```python
import torch

def _softmax(x, axis=-1):
    return torch.softmax(x, dim=axis)
def _gelu(x):
    return torch.nn.functional.gelu(x, approximate="tanh")
def _silu(x):
    return torch.nn.functional.silu(x)
def _sigmoid(x):
    return torch.sigmoid(x)
def _layernorm(x, axis=-1, eps=1e-5):
    m = x.mean(dim=axis, keepdim=True)
    v = x.var(dim=axis, keepdim=True, unbiased=False)
    return (x - m) / torch.sqrt(v + eps)
def _scatter_add(tgt, idx, src, axis=0):
    return tgt.clone().index_add_(axis, idx, src)
def _segment_sum(src, seg, n):
    out = torch.zeros((n,) + src.shape[1:], dtype=src.dtype)
    return out.index_add_(0, seg, src)
def _pad(x, pw):
    flat = tuple(v for pair in reversed(pw) for v in pair)
    return torch.nn.functional.pad(x, flat)

kernel_name = 'interleave_layers__gqa_block_cached__sliding_block_cached__decode'

def setup_inputs():

    _w = (lambda a: (lambda t: t.to(torch.bfloat16) if t.is_floating_point() else t)(torch.as_tensor(a)))
    def _A_setup():
        B, Sq, D = 1, 1, 448
        Hq, Hkv, Sk, Dh = 16, 8, 16384, 256
        assert Hq % Hkv == 0, (Hq, Hkv)
        return {
            "x": _w((lambda *s: torch.randn(*s, dtype=torch.bfloat16) * 0.1)(B, Sq, D)),
            "k_cache": _w((lambda *s: torch.randn(*s, dtype=torch.bfloat16) * 0.8)(B, Hkv, Sk, Dh)),
            "v_cache": _w((lambda *s: torch.randn(*s, dtype=torch.bfloat16) * 3.2)(B, Hkv, Sk, Dh)),
            "wq": _w((lambda *s: torch.randn(*s, dtype=torch.bfloat16) * 0.8)(D, Hq * Dh) * (D ** -0.5)),
            "wo": _w((lambda *s: torch.randn(*s, dtype=torch.bfloat16) * 3.2)(Hq * Dh, D) * ((Hq * Dh) ** -0.5)),
        }
    _A_in = _A_setup()

    def _B_setup():
        B, Sq, D = 1, 1, 448
        Hq, Hkv, Sk, Dh = 16, 8, 16384, 256
        assert Hq % Hkv == 0, (Hq, Hkv)
        return {
            "x": _w((lambda *s: torch.randn(*s, dtype=torch.bfloat16) * 0.1)(B, Sq, D)),
            "k_cache": _w((lambda *s: torch.randn(*s, dtype=torch.bfloat16) * 1.6)(B, Hkv, Sk, Dh)),
            "v_cache": _w((lambda *s: torch.randn(*s, dtype=torch.bfloat16) * 1.6)(B, Hkv, Sk, Dh)),
            "wq": _w((lambda *s: torch.randn(*s, dtype=torch.bfloat16) * 1.6)(D, Hq * Dh) * (D ** -0.5)),
            "wo": _w((lambda *s: torch.randn(*s, dtype=torch.bfloat16) * 1.6)(Hq * Dh, D) * ((Hq * Dh) ** -0.5)),
        }
    _B_in = _B_setup()

    return {
        "A_x": _A_in["x"],
        "A_k_cache": _A_in["k_cache"],
        "A_v_cache": _A_in["v_cache"],
        "A_wq": _A_in["wq"],
        "A_wo": _A_in["wo"],
        "B_x": _B_in["x"],
        "B_k_cache": _B_in["k_cache"],
        "B_v_cache": _B_in["v_cache"],
        "B_wq": _B_in["wq"],
        "B_wo": _B_in["wo"],
    }

def reference(A_x, A_k_cache, A_v_cache, A_wq, A_wo, B_x, B_k_cache, B_v_cache, B_wq, B_wo):
    def _A_ref(x, k_cache, v_cache, wq, wo):
        B, Sq, D = x.shape
        Hq, Dh = 16, 256
        Hkv = k_cache.shape[1]
        rep = Hq // Hkv
        q = (lambda x, *d: x.permute(*d))((x @ wq).reshape(B, Sq, Hq, Dh), 0, 2, 1, 3)
        k = (lambda x, n, axis: torch.repeat_interleave(x, n, dim=axis))(k_cache, rep, axis=1)
        v = (lambda x, n, axis: torch.repeat_interleave(x, n, dim=axis))(v_cache, rep, axis=1)
        scores = torch.einsum("bhqd,bhkd->bhqk", q, k) * (Dh ** -0.5)
        p = _softmax(scores, axis=-1)
        o = torch.einsum("bhqk,bhkd->bhqd", p, v)
        return (lambda x, *d: x.permute(*d))(o, 0, 2, 1, 3).reshape(B, Sq, Hq * Dh) @ wo

    def _B_ref(x, k_cache, v_cache, wq, wo):
        B, Sq, D = x.shape
        Hq, Dh = 16, 256
        Hkv, Sk = k_cache.shape[1], k_cache.shape[2]
        W = min(4096, max(256, Sk // 4))
        rep = Hq // Hkv
        q = (lambda x, *d: x.permute(*d))((x @ wq).reshape(B, Sq, Hq, Dh), 0, 2, 1, 3)
        k = (lambda x, n, axis: torch.repeat_interleave(x, n, dim=axis))(k_cache[:, :, Sk - W:, :], rep, axis=1)
        v = (lambda x, n, axis: torch.repeat_interleave(x, n, dim=axis))(v_cache[:, :, Sk - W:, :], rep, axis=1)
        scores = torch.einsum("bhqd,bhkd->bhqk", q, k) * (Dh ** -0.5)
        p = _softmax(scores, axis=-1)
        o = torch.einsum("bhqk,bhkd->bhqd", p, v)
        return (lambda x, *d: x.permute(*d))(o, 0, 2, 1, 3).reshape(B, Sq, Hq * Dh) @ wo

    x = A_x
    x = x + _A_ref(_layernorm(x, axis=-1), A_k_cache, A_v_cache, A_wq, A_wo)
    x = x + _B_ref(_layernorm(x, axis=-1), B_k_cache, B_v_cache, B_wq, B_wo)
    x = x + _A_ref(_layernorm(x, axis=-1), A_k_cache, A_v_cache, A_wq, A_wo)
    x = x + _B_ref(_layernorm(x, axis=-1), B_k_cache, B_v_cache, B_wq, B_wo)
    return x
```

```asm
; @launch grid=(256,1,1) block=(256,1,1) lds=163840
.amdgcn_target "amdgcn-amd-amdhsa--gfx950"
.text
.globl interleave_layers__gqa_block_cached__sliding_block_cached__decode_kernel
.p2align 8
.type interleave_layers__gqa_block_cached__sliding_block_cached__decode_kernel,@function
interleave_layers__gqa_block_cached__sliding_block_cached__decode_kernel:
    s_cmp_ge_u32 s2, 256
    s_cbranch_scc1 .Lend
    s_load_dwordx16 s[64:79], s[0:1], 0
    s_load_dwordx8 s[80:87], s[0:1], 64
    s_load_dwordx2 s[88:89], s[0:1], 96

    v_lshrrev_b32 v1, 6, v0
    s_and_b32 s4, s2, 7
    v_readfirstlane_b32 s3, v1
    s_lshr_b32 s5, s2, 3
    v_and_b32 v1, 63, v0
    v_lshlrev_b32 v1, 4, v1
    s_mov_b32 s6, 0x05040100
    s_mov_b32 s7, 0x07060302
    s_mov_b32 s57, 0x3db8aa3b
    s_mov_b32 s53, 0x3f803f80
    s_mov_b32 s62, 0x40000
    s_mov_b32 s58, 0
    s_mov_b32 s59, 0
    s_mov_b32 s52, 131072
    s_lshl_b32 s63, s3, 14
    s_lshl_b32 s54, s4, 23
    s_lshl_b32 s56, s5, 13
    s_add_u32 s54, s54, s56
    s_add_u32 s55, s54, 6291456
    s_lshl_b32 s56, s3, 21
    s_add_u32 s54, s54, s56
    s_lshl_b32 s56, s3, 18
    s_add_u32 s55, s55, s56
    v_bfe_u32 v58, v1, 4, 4
    v_bfe_u32 v59, v1, 8, 2
    v_lshlrev_b32 v3, 11, v59
    v_lshl_add_u32 v3, v58, 4, v3
    v_bfe_u32 v63, v1, 5, 1
    v_lshlrev_b32 v63, 9, v63
    v_lshl_add_u32 v63, v59, 4, v63
    v_and_b32 v59, 16, v1
    v_lshl_add_u32 v63, v59, 2, v63
    v_lshrrev_b32 v58, 2, v58
    v_lshl_add_u32 v2, v58, 11, v63
    v_add_u32 v63, 159872, v63
    v_mov_b32 v62, 0xffff
    v_lshlrev_b32 v62, v59, v62
    v_mov_b32 v4, 161664
    v_mov_b32 v5, 161664
    v_mov_b32 v6, 161664
    v_mov_b32 v7, 161664
    s_nop 0
    v_mov_b32_dpp v4, v63 quad_perm:[0,1,2,3] row_mask:0xf bank_mask:0x1
    v_mov_b32_dpp v5, v63 quad_perm:[0,1,2,3] row_mask:0xf bank_mask:0x2
    v_mov_b32_dpp v6, v63 quad_perm:[0,1,2,3] row_mask:0xf bank_mask:0x4
    v_mov_b32_dpp v7, v63 quad_perm:[0,1,2,3] row_mask:0xf bank_mask:0x8
    s_waitcnt lgkmcnt(0)
    s_load_dword s90, s[88:89], 851968
    s_mov_b32 s28, s70
    s_mov_b32 s29, s71
    s_mov_b32 s30, 0x380000
    s_mov_b32 s31, 0x20000
    s_mov_b32 s32, s72
    s_mov_b32 s33, s73
    s_mov_b32 s34, 0x380000
    s_mov_b32 s35, 0x20000
    s_mov_b32 s36, s64
    s_mov_b32 s37, s65
    s_mov_b32 s38, 0x380
    s_mov_b32 s39, 0x20000
    s_cmp_eq_u32 s3, 1
    s_cselect_b32 s28, s80, s28
    s_cselect_b32 s29, s81, s29
    s_cmp_eq_u32 s3, 3
    s_cselect_b32 s32, s82, s32
    s_cselect_b32 s33, s83, s33
    s_mov_b32 m0, 161408
    s_cmp_ge_u32 s3, 2
    s_cbranch_scc1 .Lst_wo

    v_lshrrev_b32 v58, 7, v1
    v_lshlrev_b32 v58, 13, v58
    v_and_b32 v59, 0x70, v1
    v_lshl_add_u32 v58, v59, 3, v58
    s_lshl_b32 s56, s4, 10
    s_mul_i32 s60, s5, 114688
    s_add_u32 s56, s56, s60
    s_add_u32 s60, s56, 49152
    buffer_load_dword v58, s[28:31], s56 offen  lds
    buffer_load_dword v58, s[28:31], s60 offen  lds
    s_branch .Lst_j
.Lst_wo:
    s_cmp_eq_u32 s3, 3
    s_cbranch_scc1 .Lst_j
    v_lshlrev_b32 v58, 3, v1
    s_lshl_b32 s60, s4, 5
    s_add_u32 s60, s60, s5
    s_mul_i32 s60, s60, 14336
    s_add_u32 s61, s60, 6144
    buffer_load_dword v58, s[32:35], s60 offen lds
    buffer_load_dword v58, s[32:35], s61 offen lds
.Lst_j:
    s_mov_b64 s[28:29], s[70:71]
    s_mov_b32 s51, 131072
    s_call_b64 s[64:65], sub_wq
    s_cmp_lg_u32 s3, 0
    s_cbranch_scc1 .ow1
    v_bfe_u32 v6, v1, 8, 2
    v_mul_u32_u24 v7, 448, v6
    v_mul_u32_u24 v6, 3584, v6
    v_bfe_u32 v4, v1, 4, 4
    v_lshl_add_u32 v6, v4, 3, v6
    v_add_u32 v6, s52, v6
    v_lshl_add_u32 v7, v4, 5, v7
    v_cmp_gt_u32 vcc, 14, v4
    v_mov_b32 v4, 4096
    s_nop 0
    v_cndmask_b32 v7, v4, v7, vcc
    v_lshrrev_b32 v47, 1, v7
    buffer_load_dwordx4 v[40:43], v47, s[36:39], 0 offen
.ow1:
    v_and_b32 v48, 0x70, v1
    v_lshrrev_b32 v48, 1, v48
    v_lshrrev_b32 v49, 9, v1
    v_lshl_add_u32 v48, v49, 2, v48
    s_sub_u32 s60, s5, 28
    s_lshl_b32 s60, s60, 2
    s_add_u32 s60, s60, s3
    s_lshl_b32 s60, s60, 6
    v_add_u32 v48, s60, v48
    buffer_load_dword v53, v48, s[36:39], 0 offen
    s_mov_b32 s8, s66
    s_mov_b32 s9, s67
    s_mov_b32 s10, 0x4000000
    s_mov_b32 s11, 0x20000
    s_mov_b32 s12, s68
    s_mov_b32 s13, s69
    s_mov_b32 s14, 0x4000000
    s_mov_b32 s15, 0x20000
    s_add_u32 s50, s4, 6
    s_and_b32 s50, s50, 7
    s_lshl_b32 s50, s50, 18
    s_add_u32 s50, s50, s54
    s_mov_b32 s42, s50
    s_add_u32 s51, s63, 65536
    s_call_b64 s[64:65], sub_dmaX
    s_mov_b32 s24, s88
    s_mov_b32 s25, s89
    s_mov_b32 s26, 0x800000
    s_mov_b32 s27, 0x20000
    s_mov_b32 s16, s76
    s_mov_b32 s17, s77
    s_mov_b32 s18, 0x4000000
    s_mov_b32 s19, 0x20000
    s_mov_b32 s20, s78
    s_mov_b32 s21, s79
    s_mov_b32 s22, 0x4000000
    s_mov_b32 s23, 0x20000
    s_mov_b64 s[44:45], s[72:73]
    s_mov_b64 s[46:47], s[82:83]
    s_mov_b64 s[48:49], s[84:85]
    s_mov_b64 s[32:33], s[72:73]
    s_mov_b64 s[28:29], s[80:81]
    s_mov_b32 s2, 0
    s_add_u32 s66, s63, 65536
    s_mov_b32 s68, 1
    s_cmp_ge_u32 s5, 14
    s_cselect_b32 s60, 1, 0
    s_mul_i32 s61, s60, 14
    s_sub_u32 s61, s5, s61
    s_lshl_b32 s67, s4, 1
    s_add_u32 s67, s67, s60
    s_mul_i32 s67, s67, 229376
    s_lshl_b32 s61, s61, 6
    s_add_u32 s67, s67, s61
    s_mul_i32 s56, s3, 57344
    s_add_u32 s82, s67, s56
    s_add_u32 s83, s82, 7168
    s_add_u32 s84, s82, 14336
    s_add_u32 s85, s82, 21504
    s_lshl_b32 s56, s4, 16
    s_lshl_b32 s61, s5, 11
    s_add_u32 s69, s56, s61
    s_lshl_b32 s61, s60, 10
    s_add_u32 s56, s56, s61
    s_lshl_b32 s61, s3, 8
    s_add_u32 s78, s56, s61
    s_add_u32 s79, s78, 4096
    s_add_u32 s80, s78, 8192
    s_add_u32 s81, s78, 12288
    s_lshl_b32 s56, s4, 10
    s_add_u32 s56, s56, 786432
    s_lshl_b32 s61, s5, 4
    s_add_u32 s70, s56, s61
    s_lshl_b32 s61, s60, 9
    s_add_u32 s71, s56, s61
    s_mul_i32 s56, s4, 28
    s_add_u32 s56, s56, s5
    s_lshl_b32 s56, s56, 7
    s_add_u32 s72, s56, 524288
    s_lshl_b32 s56, s4, 11
    s_add_u32 s75, s56, 794624
    s_add_u32 s76, s56, 819200
    s_lshl_b32 s61, s5, 6
    s_add_u32 s77, s76, s61
    s_waitcnt lgkmcnt(0)
    s_sub_u32 s88, s5, 28
    s_lshl_b32 s88, s88, 2
    s_add_u32 s88, s88, s3
    s_lshl_b32 s56, s4, 15
    s_lshl_b32 s61, s88, 7
    s_add_u32 s56, s56, s61
    s_add_u32 s73, s56, 524288
    s_add_u32 s74, s73, 14336
    s_add_u32 s90, s90, 0x1010101
    s_and_b32 s86, s90, 0xffff
    s_lshr_b32 s87, s90, 16
    s_mov_b32 s89, 0
    s_add_u32 s50, s4, 7
    s_and_b32 s50, s50, 7
    s_lshl_b32 s50, s50, 18
    s_add_u32 s50, s50, s54
    s_mov_b32 s43, s50
    s_add_u32 s51, s63, 73728
    s_call_b64 s[64:65], sub_dmaX
    s_mov_b32 s51, 145408
    s_call_b64 s[64:65], sub_wq
    v_mov_b32 v46, 0
    v_mov_b32 v47, 0
    v_mov_b32 v45, 159808
    ds_write_b64 v45, v[46:47]
    v_lshrrev_b32 v45, 1, v1
    v_add_u32 v45, 161664, v45
    ds_write_b64 v45, v[46:47]
    s_waitcnt lgkmcnt(0)
    s_waitcnt vmcnt(16)
    s_barrier
    v_lshrrev_b32 v48, 2, v1
    s_lshl_b32 s56, s3, 8
    s_add_u32 s56, s56, 162176
    v_add_u32 v48, s56, v48
    ds_write_b32 v48, v53
    s_cmp_lg_u32 s3, 0
    s_cbranch_scc1 .ow2
    ds_read_b64_tr_b16 v[8:9], v6 offset:0
    ds_read_b64_tr_b16 v[10:11], v6 offset:128
    ds_read_b64_tr_b16 v[12:13], v6 offset:256
    ds_read_b64_tr_b16 v[14:15], v6 offset:384
    ds_read_b64_tr_b16 v[16:17], v6 offset:512
    ds_read_b64_tr_b16 v[18:19], v6 offset:640
    ds_read_b64_tr_b16 v[20:21], v6 offset:768
    ds_read_b64_tr_b16 v[22:23], v6 offset:896
    ds_read_b64_tr_b16 v[24:25], v6 offset:1024
    ds_read_b64_tr_b16 v[26:27], v6 offset:1152
    ds_read_b64_tr_b16 v[28:29], v6 offset:1280
    ds_read_b64_tr_b16 v[30:31], v6 offset:1408
    ds_read_b64_tr_b16 v[32:33], v6 offset:1536
    ds_read_b64_tr_b16 v[34:35], v6 offset:1664
    ds_read_b64_tr_b16 v[36:37], v6 offset:1792
    ds_read_b64_tr_b16 v[38:39], v6 offset:1920
    ds_read_b64_tr_b16 v[56:57], v6 offset:2048
    ds_read_b64_tr_b16 v[58:59], v6 offset:2176
    ds_read_b64_tr_b16 v[60:61], v6 offset:2304
    ds_read_b64_tr_b16 v[62:63], v6 offset:2432
    s_call_b64 s[64:65], sub_s3b
    s_getreg_b32 s60, hwreg(HW_REG_XCC_ID, 0, 4)
    s_mul_i32 s61, s5, 48
    s_sub_u32 s61, 16384, s61
    v_writelane_b32 v40, s60, 1
    v_writelane_b32 v41, s90, 1
    v_writelane_b32 v48, s61, 1
    s_mov_b32 exec_lo, 0x10003
    s_mov_b32 exec_hi, 0x10001
    buffer_store_dwordx4 v[40:43], v48, s[24:27], s77 offen sc1
    s_mov_b64 exec, -1
    s_mov_b32 s2, 1
    v_bfe_u32 v58, v1, 4, 4
    v_bfe_u32 v59, v1, 8, 2
    v_lshlrev_b32 v3, 11, v59
    v_lshl_add_u32 v3, v58, 4, v3
    v_bfe_u32 v63, v1, 5, 1
    v_lshlrev_b32 v63, 9, v63
    v_lshl_add_u32 v63, v59, 4, v63
    v_and_b32 v59, 16, v1
    v_lshl_add_u32 v63, v59, 2, v63
    v_lshrrev_b32 v58, 2, v58
    v_lshl_add_u32 v2, v58, 11, v63
    v_add_u32 v63, 159872, v63
    v_mov_b32 v62, 0xffff
    v_lshlrev_b32 v62, v59, v62
    v_mov_b32 v4, 161664
    v_mov_b32 v5, 161664
    v_mov_b32 v6, 161664
    v_mov_b32 v7, 161664
    s_nop 0
    v_mov_b32_dpp v4, v63 quad_perm:[0,1,2,3] row_mask:0xf bank_mask:0x1
    v_mov_b32_dpp v5, v63 quad_perm:[0,1,2,3] row_mask:0xf bank_mask:0x2
    v_mov_b32_dpp v6, v63 quad_perm:[0,1,2,3] row_mask:0xf bank_mask:0x4
    v_mov_b32_dpp v7, v63 quad_perm:[0,1,2,3] row_mask:0xf bank_mask:0x8
.ow2:
    s_add_u32 s56, s4, 0
    s_and_b32 s56, s56, 7
    s_lshl_b32 s56, s56, 18
    s_add_u32 s56, s56, s54
    buffer_load_dwordx4 a[0:3], v2, s[8:11], s56 offen offset:0 nt
    buffer_load_dwordx4 a[4:7], v2, s[8:11], s56 offen offset:1024 nt
    buffer_load_dwordx4 a[8:11], v2, s[8:11], s56 offen offset:128 nt
    buffer_load_dwordx4 a[12:15], v2, s[8:11], s56 offen offset:1152 nt
    buffer_load_dwordx4 a[16:19], v2, s[8:11], s56 offen offset:256 nt
    buffer_load_dwordx4 a[20:23], v2, s[8:11], s56 offen offset:1280 nt
    buffer_load_dwordx4 a[24:27], v2, s[8:11], s56 offen offset:384 nt
    buffer_load_dwordx4 a[28:31], v2, s[8:11], s56 offen offset:1408 nt
    s_add_u32 s56, s4, 1
    s_and_b32 s56, s56, 7
    s_lshl_b32 s56, s56, 18
    s_add_u32 s56, s56, s54
    buffer_load_dwordx4 a[32:35], v2, s[8:11], s56 offen offset:0 nt
    buffer_load_dwordx4 a[36:39], v2, s[8:11], s56 offen offset:1024 nt
    buffer_load_dwordx4 a[40:43], v2, s[8:11], s56 offen offset:128 nt
    buffer_load_dwordx4 a[44:47], v2, s[8:11], s56 offen offset:1152 nt
    buffer_load_dwordx4 a[48:51], v2, s[8:11], s56 offen offset:256 nt
    buffer_load_dwordx4 a[52:55], v2, s[8:11], s56 offen offset:1280 nt
    buffer_load_dwordx4 a[56:59], v2, s[8:11], s56 offen offset:384 nt
    buffer_load_dwordx4 a[60:63], v2, s[8:11], s56 offen offset:1408 nt
    s_add_u32 s56, s4, 2
    s_and_b32 s56, s56, 7
    s_lshl_b32 s56, s56, 18
    s_add_u32 s56, s56, s54
    buffer_load_dwordx4 a[64:67], v2, s[8:11], s56 offen offset:0 nt
    buffer_load_dwordx4 a[68:71], v2, s[8:11], s56 offen offset:1024 nt
    buffer_load_dwordx4 a[72:75], v2, s[8:11], s56 offen offset:128 nt
    buffer_load_dwordx4 a[76:79], v2, s[8:11], s56 offen offset:1152 nt
    buffer_load_dwordx4 a[80:83], v2, s[8:11], s56 offen offset:256 nt
    buffer_load_dwordx4 a[84:87], v2, s[8:11], s56 offen offset:1280 nt
    buffer_load_dwordx4 a[88:91], v2, s[8:11], s56 offen offset:384 nt
    buffer_load_dwordx4 a[92:95], v2, s[8:11], s56 offen offset:1408 nt
    s_add_u32 s56, s4, 3
    s_and_b32 s56, s56, 7
    s_lshl_b32 s56, s56, 18
    s_add_u32 s56, s56, s54
    buffer_load_dwordx4 a[96:99], v2, s[8:11], s56 offen offset:0 nt
    buffer_load_dwordx4 a[100:103], v2, s[8:11], s56 offen offset:1024 nt
    buffer_load_dwordx4 a[104:107], v2, s[8:11], s56 offen offset:128 nt
    buffer_load_dwordx4 a[108:111], v2, s[8:11], s56 offen offset:1152 nt
    buffer_load_dwordx4 a[112:115], v2, s[8:11], s56 offen offset:256 nt
    buffer_load_dwordx4 a[116:119], v2, s[8:11], s56 offen offset:1280 nt
    buffer_load_dwordx4 a[120:123], v2, s[8:11], s56 offen offset:384 nt
    buffer_load_dwordx4 a[124:127], v2, s[8:11], s56 offen offset:1408 nt
    s_add_u32 s56, s4, 4
    s_and_b32 s56, s56, 7
    s_lshl_b32 s56, s56, 18
    s_add_u32 s56, s56, s54
    buffer_load_dwordx4 a[128:131], v2, s[8:11], s56 offen offset:0 nt
    buffer_load_dwordx4 a[132:135], v2, s[8:11], s56 offen offset:1024 nt
    buffer_load_dwordx4 a[136:139], v2, s[8:11], s56 offen offset:128 nt
    buffer_load_dwordx4 a[140:143], v2, s[8:11], s56 offen offset:1152 nt
    buffer_load_dwordx4 a[144:147], v2, s[8:11], s56 offen offset:256 nt
    buffer_load_dwordx4 a[148:151], v2, s[8:11], s56 offen offset:1280 nt
    buffer_load_dwordx4 a[152:155], v2, s[8:11], s56 offen offset:384 nt
    buffer_load_dwordx4 a[156:159], v2, s[8:11], s56 offen offset:1408 nt
    s_cmp_lg_u32 s3, 3
    s_cbranch_scc1 .ow3
    s_call_b64 s[64:65], sub_g0issue
.ow3:
    s_add_u32 s56, s4, 5
    s_and_b32 s56, s56, 7
    s_lshl_b32 s56, s56, 18
    s_add_u32 s56, s56, s54
    buffer_load_dwordx4 a[160:163], v2, s[8:11], s56 offen offset:0 nt
    buffer_load_dwordx4 a[164:167], v2, s[8:11], s56 offen offset:1024 nt
    buffer_load_dwordx4 a[168:171], v2, s[8:11], s56 offen offset:128 nt
    buffer_load_dwordx4 a[172:175], v2, s[8:11], s56 offen offset:1152 nt
    buffer_load_dwordx4 a[176:179], v2, s[8:11], s56 offen offset:256 nt
    buffer_load_dwordx4 a[180:183], v2, s[8:11], s56 offen offset:1280 nt
    buffer_load_dwordx4 a[184:187], v2, s[8:11], s56 offen offset:384 nt
    buffer_load_dwordx4 a[188:191], v2, s[8:11], s56 offen offset:1408 nt
    s_cmp_lg_u32 s3, 3
    s_cbranch_scc1 .ow4
    s_cmp_lg_u32 s2, 0
    s_cbranch_scc1 .ow4
    s_waitcnt vmcnt(8)
    s_call_b64 s[64:65], sub_g0check
    s_cmp_lg_u32 s2, 0
    s_cbranch_scc1 .ow4
    s_call_b64 s[64:65], sub_g0issue
.ow4:
    s_add_u32 s56, s4, 6
    s_and_b32 s56, s56, 7
    s_lshl_b32 s56, s56, 18
    s_add_u32 s56, s56, s54
    buffer_load_dwordx4 a[192:195], v2, s[8:11], s56 offen offset:0 nt
    buffer_load_dwordx4 a[196:199], v2, s[8:11], s56 offen offset:1024 nt
    buffer_load_dwordx4 a[200:203], v2, s[8:11], s56 offen offset:128 nt
    buffer_load_dwordx4 a[204:207], v2, s[8:11], s56 offen offset:1152 nt
    buffer_load_dwordx4 a[208:211], v2, s[8:11], s56 offen offset:256 nt
    buffer_load_dwordx4 a[212:215], v2, s[8:11], s56 offen offset:1280 nt
    buffer_load_dwordx4 a[216:219], v2, s[8:11], s56 offen offset:384 nt
    buffer_load_dwordx4 a[220:223], v2, s[8:11], s56 offen offset:1408 nt
    s_cmp_lg_u32 s3, 3
    s_cbranch_scc1 .ow5
    s_cmp_lg_u32 s2, 0
    s_cbranch_scc1 .ow5
    s_waitcnt vmcnt(8)
    s_call_b64 s[64:65], sub_g0check
    s_cmp_lg_u32 s2, 0
    s_cbranch_scc1 .ow5
    s_call_b64 s[64:65], sub_g0issue
.ow5:
    s_add_u32 s56, s4, 7
    s_and_b32 s56, s56, 7
    s_lshl_b32 s56, s56, 18
    s_add_u32 s56, s56, s54
    buffer_load_dwordx4 a[224:227], v2, s[8:11], s56 offen offset:0 nt
    buffer_load_dwordx4 a[228:231], v2, s[8:11], s56 offen offset:1024 nt
    buffer_load_dwordx4 a[232:235], v2, s[8:11], s56 offen offset:128 nt
    buffer_load_dwordx4 a[236:239], v2, s[8:11], s56 offen offset:1152 nt
    buffer_load_dwordx4 a[240:243], v2, s[8:11], s56 offen offset:256 nt
    buffer_load_dwordx4 a[244:247], v2, s[8:11], s56 offen offset:1280 nt
    buffer_load_dwordx4 a[248:251], v2, s[8:11], s56 offen offset:384 nt
    buffer_load_dwordx4 a[252:255], v2, s[8:11], s56 offen offset:1408 nt
    s_cmp_lg_u32 s3, 3
    s_cbranch_scc1 .ow6
    s_cmp_lg_u32 s2, 0
    s_cbranch_scc1 .ow6
    s_waitcnt vmcnt(8)
.Lg0loop:
    s_call_b64 s[64:65], sub_g0check
    s_cmp_lg_u32 s2, 0
    s_cbranch_scc1 .ow6
    s_call_b64 s[64:65], sub_g0issue
    s_waitcnt vmcnt(0)
    s_branch .Lg0loop
.ow6:
    s_add_u32 s90, s90, 0x1010101
    s_add_u32 s56, s4, 0
    s_and_b32 s56, s56, 7
    s_lshl_b32 s56, s56, 18
    s_add_u32 s56, s56, s54
    buffer_load_dwordx4 v[64:67], v3, s[12:15], s56 offen offset:0 nt
    buffer_load_dwordx4 v[68:71], v3, s[12:15], s56 offen offset:256 nt
    buffer_load_dwordx4 v[72:75], v3, s[12:15], s56 offen offset:512 nt
    buffer_load_dwordx4 v[76:79], v3, s[12:15], s56 offen offset:768 nt
    buffer_load_dwordx4 v[80:83], v3, s[12:15], s56 offen offset:1024 nt
    buffer_load_dwordx4 v[84:87], v3, s[12:15], s56 offen offset:1280 nt
    buffer_load_dwordx4 v[88:91], v3, s[12:15], s56 offen offset:1536 nt
    buffer_load_dwordx4 v[92:95], v3, s[12:15], s56 offen offset:1792 nt
    s_add_u32 s56, s4, 1
    s_and_b32 s56, s56, 7
    s_lshl_b32 s56, s56, 18
    s_add_u32 s56, s56, s54
    buffer_load_dwordx4 v[96:99], v3, s[12:15], s56 offen offset:0 nt
    buffer_load_dwordx4 v[100:103], v3, s[12:15], s56 offen offset:256 nt
    buffer_load_dwordx4 v[104:107], v3, s[12:15], s56 offen offset:512 nt
    buffer_load_dwordx4 v[108:111], v3, s[12:15], s56 offen offset:768 nt
    buffer_load_dwordx4 v[112:115], v3, s[12:15], s56 offen offset:1024 nt
    buffer_load_dwordx4 v[116:119], v3, s[12:15], s56 offen offset:1280 nt
    buffer_load_dwordx4 v[120:123], v3, s[12:15], s56 offen offset:1536 nt
    buffer_load_dwordx4 v[124:127], v3, s[12:15], s56 offen offset:1792 nt
    v_mov_b32 v46, 159808
.Lqflag:
    ds_read_b32 v44, v46
    s_waitcnt lgkmcnt(0)
    v_readfirstlane_b32 s58, v44
    s_nop 3
    s_cmp_eq_u32 s58, 0
    s_cbranch_scc1 .Lqflag
    s_sub_u32 s58, s58, 1
    s_waitcnt vmcnt(16)
    s_call_b64 s[64:65], sub_qka0
    s_add_u32 s56, s4, 2
    s_and_b32 s56, s56, 7
    s_lshl_b32 s56, s56, 18
    s_add_u32 s56, s56, s54
    buffer_load_dwordx4 v[128:131], v3, s[12:15], s56 offen offset:0 nt
    buffer_load_dwordx4 v[132:135], v3, s[12:15], s56 offen offset:256 nt
    buffer_load_dwordx4 v[136:139], v3, s[12:15], s56 offen offset:512 nt
    buffer_load_dwordx4 v[140:143], v3, s[12:15], s56 offen offset:768 nt
    buffer_load_dwordx4 v[144:147], v3, s[12:15], s56 offen offset:1024 nt
    buffer_load_dwordx4 v[148:151], v3, s[12:15], s56 offen offset:1280 nt
    buffer_load_dwordx4 v[152:155], v3, s[12:15], s56 offen offset:1536 nt
    buffer_load_dwordx4 v[156:159], v3, s[12:15], s56 offen offset:1792 nt
    s_call_b64 s[64:65], sub_qka1
    s_add_u32 s56, s4, 3
    s_and_b32 s56, s56, 7
    s_lshl_b32 s56, s56, 18
    s_add_u32 s56, s56, s54
    buffer_load_dwordx4 v[160:163], v3, s[12:15], s56 offen offset:0 nt
    buffer_load_dwordx4 v[164:167], v3, s[12:15], s56 offen offset:256 nt
    buffer_load_dwordx4 v[168:171], v3, s[12:15], s56 offen offset:512 nt
    buffer_load_dwordx4 v[172:175], v3, s[12:15], s56 offen offset:768 nt
    buffer_load_dwordx4 v[176:179], v3, s[12:15], s56 offen offset:1024 nt
    buffer_load_dwordx4 v[180:183], v3, s[12:15], s56 offen offset:1280 nt
    buffer_load_dwordx4 v[184:187], v3, s[12:15], s56 offen offset:1536 nt
    buffer_load_dwordx4 v[188:191], v3, s[12:15], s56 offen offset:1792 nt
    s_call_b64 s[64:65], sub_pvlds
    s_waitcnt vmcnt(16)
    s_call_b64 s[64:65], sub_pv01
    s_add_u32 s56, s4, 4
    s_and_b32 s56, s56, 7
    s_lshl_b32 s56, s56, 18
    s_add_u32 s56, s56, s54
    buffer_load_dwordx4 v[192:195], v3, s[12:15], s56 offen offset:0 nt
    buffer_load_dwordx4 v[196:199], v3, s[12:15], s56 offen offset:256 nt
    buffer_load_dwordx4 v[200:203], v3, s[12:15], s56 offen offset:512 nt
    buffer_load_dwordx4 v[204:207], v3, s[12:15], s56 offen offset:768 nt
    buffer_load_dwordx4 v[208:211], v3, s[12:15], s56 offen offset:1024 nt
    buffer_load_dwordx4 v[212:215], v3, s[12:15], s56 offen offset:1280 nt
    buffer_load_dwordx4 v[216:219], v3, s[12:15], s56 offen offset:1536 nt
    buffer_load_dwordx4 v[220:223], v3, s[12:15], s56 offen offset:1792 nt
    s_waitcnt vmcnt(8)
    s_call_b64 s[64:65], sub_pv23
    s_add_u32 s56, s4, 5
    s_and_b32 s56, s56, 7
    s_lshl_b32 s56, s56, 18
    s_add_u32 s56, s56, s54
    buffer_load_dwordx4 v[224:227], v3, s[12:15], s56 offen offset:0 nt
    buffer_load_dwordx4 v[228:231], v3, s[12:15], s56 offen offset:256 nt
    buffer_load_dwordx4 v[232:235], v3, s[12:15], s56 offen offset:512 nt
    buffer_load_dwordx4 v[236:239], v3, s[12:15], s56 offen offset:768 nt
    buffer_load_dwordx4 v[240:243], v3, s[12:15], s56 offen offset:1024 nt
    buffer_load_dwordx4 v[244:247], v3, s[12:15], s56 offen offset:1280 nt
    buffer_load_dwordx4 v[248:251], v3, s[12:15], s56 offen offset:1536 nt
    buffer_load_dwordx4 v[252:255], v3, s[12:15], s56 offen offset:1792 nt
    s_waitcnt vmcnt(8)
    s_call_b64 s[64:65], sub_pv4
    s_waitcnt vmcnt(4)
    s_branch sub_pv5
.LlayerA:
    ds_read_b128 v[32:35], v4 offset:0
    ds_read_b128 v[36:39], v5 offset:0
    ds_read_b128 v[40:43], v4 offset:128
    ds_read_b128 v[44:47], v5 offset:128
    ds_read_b128 v[48:51], v4 offset:256
    ds_read_b128 v[52:55], v5 offset:256
    s_waitcnt lgkmcnt(5)
    v_mfma_f32_16x16x32_bf16 v[16:19], a[0:3], v[32:35], 0
    v_mfma_f32_16x16x32_bf16 v[20:23], a[4:7], v[32:35], 0
    v_mfma_f32_16x16x32_bf16 v[24:27], a[128:131], v[32:35], 0
    v_mfma_f32_16x16x32_bf16 v[28:31], a[132:135], v[32:35], 0
    s_waitcnt lgkmcnt(4)
    v_mfma_f32_16x16x32_bf16 v[16:19], a[32:35], v[36:39], v[16:19]
    v_mfma_f32_16x16x32_bf16 v[20:23], a[36:39], v[36:39], v[20:23]
    v_mfma_f32_16x16x32_bf16 v[24:27], a[160:163], v[36:39], v[24:27]
    v_mfma_f32_16x16x32_bf16 v[28:31], a[164:167], v[36:39], v[28:31]
    ds_read_b128 v[32:35], v4 offset:384
    s_waitcnt lgkmcnt(4)
    v_mfma_f32_16x16x32_bf16 v[16:19], a[8:11], v[40:43], v[16:19]
    v_mfma_f32_16x16x32_bf16 v[20:23], a[12:15], v[40:43], v[20:23]
    v_mfma_f32_16x16x32_bf16 v[24:27], a[136:139], v[40:43], v[24:27]
    v_mfma_f32_16x16x32_bf16 v[28:31], a[140:143], v[40:43], v[28:31]
    ds_read_b128 v[36:39], v5 offset:384
    s_waitcnt lgkmcnt(4)
    v_mfma_f32_16x16x32_bf16 v[16:19], a[40:43], v[44:47], v[16:19]
    v_mfma_f32_16x16x32_bf16 v[20:23], a[44:47], v[44:47], v[20:23]
    v_mfma_f32_16x16x32_bf16 v[24:27], a[168:171], v[44:47], v[24:27]
    v_mfma_f32_16x16x32_bf16 v[28:31], a[172:175], v[44:47], v[28:31]
    ds_read_b128 v[40:43], v6 offset:0
    s_waitcnt lgkmcnt(4)
    v_mfma_f32_16x16x32_bf16 v[16:19], a[16:19], v[48:51], v[16:19]
    v_mfma_f32_16x16x32_bf16 v[20:23], a[20:23], v[48:51], v[20:23]
    v_mfma_f32_16x16x32_bf16 v[24:27], a[144:147], v[48:51], v[24:27]
    v_mfma_f32_16x16x32_bf16 v[28:31], a[148:151], v[48:51], v[28:31]
    ds_read_b128 v[44:47], v7 offset:0
    s_waitcnt lgkmcnt(4)
    v_mfma_f32_16x16x32_bf16 v[16:19], a[48:51], v[52:55], v[16:19]
    v_mfma_f32_16x16x32_bf16 v[20:23], a[52:55], v[52:55], v[20:23]
    v_mfma_f32_16x16x32_bf16 v[24:27], a[176:179], v[52:55], v[24:27]
    v_mfma_f32_16x16x32_bf16 v[28:31], a[180:183], v[52:55], v[28:31]
    ds_read_b128 v[48:51], v6 offset:128
    s_waitcnt lgkmcnt(4)
    v_mfma_f32_16x16x32_bf16 v[16:19], a[24:27], v[32:35], v[16:19]
    v_mfma_f32_16x16x32_bf16 v[20:23], a[28:31], v[32:35], v[20:23]
    v_mfma_f32_16x16x32_bf16 v[24:27], a[152:155], v[32:35], v[24:27]
    v_mfma_f32_16x16x32_bf16 v[28:31], a[156:159], v[32:35], v[28:31]
    ds_read_b128 v[52:55], v7 offset:128
    s_waitcnt lgkmcnt(4)
    v_mfma_f32_16x16x32_bf16 v[16:19], a[56:59], v[36:39], v[16:19]
    v_mfma_f32_16x16x32_bf16 v[20:23], a[60:63], v[36:39], v[20:23]
    v_mfma_f32_16x16x32_bf16 v[24:27], a[184:187], v[36:39], v[24:27]
    v_mfma_f32_16x16x32_bf16 v[28:31], a[188:191], v[36:39], v[28:31]
    ds_read_b128 v[32:35], v6 offset:256
    s_waitcnt lgkmcnt(4)
    v_mfma_f32_16x16x32_bf16 v[16:19], a[64:67], v[40:43], v[16:19]
    v_mfma_f32_16x16x32_bf16 v[20:23], a[68:71], v[40:43], v[20:23]
    buffer_load_dwordx4 a[0:3], v3, s[12:15], s42 offen offset:0
    v_mfma_f32_16x16x32_bf16 v[24:27], a[192:195], v[40:43], v[24:27]
    v_mfma_f32_16x16x32_bf16 v[28:31], a[196:199], v[40:43], v[28:31]
    ds_read_b128 v[36:39], v7 offset:256
    s_waitcnt lgkmcnt(4)
    v_mfma_f32_16x16x32_bf16 v[16:19], a[96:99], v[44:47], v[16:19]
    v_mfma_f32_16x16x32_bf16 v[20:23], a[100:103], v[44:47], v[20:23]
    buffer_load_dwordx4 a[4:7], v3, s[12:15], s42 offen offset:256
    v_mfma_f32_16x16x32_bf16 v[24:27], a[224:227], v[44:47], v[24:27]
    v_mfma_f32_16x16x32_bf16 v[28:31], a[228:231], v[44:47], v[28:31]
    ds_read_b128 v[40:43], v6 offset:384
    s_waitcnt lgkmcnt(4)
    v_mfma_f32_16x16x32_bf16 v[16:19], a[72:75], v[48:51], v[16:19]
    v_mfma_f32_16x16x32_bf16 v[20:23], a[76:79], v[48:51], v[20:23]
    buffer_load_dwordx4 a[8:11], v3, s[12:15], s42 offen offset:512
    v_mfma_f32_16x16x32_bf16 v[24:27], a[200:203], v[48:51], v[24:27]
    v_mfma_f32_16x16x32_bf16 v[28:31], a[204:207], v[48:51], v[28:31]
    ds_read_b128 v[44:47], v7 offset:384
    s_waitcnt lgkmcnt(4)
    v_mfma_f32_16x16x32_bf16 v[16:19], a[104:107], v[52:55], v[16:19]
    v_mfma_f32_16x16x32_bf16 v[20:23], a[108:111], v[52:55], v[20:23]
    buffer_load_dwordx4 a[12:15], v3, s[12:15], s42 offen offset:768
    v_mfma_f32_16x16x32_bf16 v[24:27], a[232:235], v[52:55], v[24:27]
    v_mfma_f32_16x16x32_bf16 v[28:31], a[236:239], v[52:55], v[28:31]
    s_waitcnt lgkmcnt(3)
    v_mfma_f32_16x16x32_bf16 v[16:19], a[80:83], v[32:35], v[16:19]
    v_mfma_f32_16x16x32_bf16 v[20:23], a[84:87], v[32:35], v[20:23]
    buffer_load_dwordx4 a[16:19], v3, s[12:15], s42 offen offset:1024
    v_mfma_f32_16x16x32_bf16 v[24:27], a[208:211], v[32:35], v[24:27]
    v_mfma_f32_16x16x32_bf16 v[28:31], a[212:215], v[32:35], v[28:31]
    s_waitcnt lgkmcnt(2)
    v_mfma_f32_16x16x32_bf16 v[16:19], a[112:115], v[36:39], v[16:19]
    v_mfma_f32_16x16x32_bf16 v[20:23], a[116:119], v[36:39], v[20:23]
    buffer_load_dwordx4 a[20:23], v3, s[12:15], s42 offen offset:1280
    v_mfma_f32_16x16x32_bf16 v[24:27], a[240:243], v[36:39], v[24:27]
    v_mfma_f32_16x16x32_bf16 v[28:31], a[244:247], v[36:39], v[28:31]
    s_waitcnt lgkmcnt(1)
    v_mfma_f32_16x16x32_bf16 v[16:19], a[88:91], v[40:43], v[16:19]
    v_mfma_f32_16x16x32_bf16 v[20:23], a[92:95], v[40:43], v[20:23]
    buffer_load_dwordx4 a[24:27], v3, s[12:15], s42 offen offset:1536
    v_mfma_f32_16x16x32_bf16 v[24:27], a[216:219], v[40:43], v[24:27]
    v_mfma_f32_16x16x32_bf16 v[28:31], a[220:223], v[40:43], v[28:31]
    s_waitcnt lgkmcnt(0)
    v_mfma_f32_16x16x32_bf16 v[16:19], a[120:123], v[44:47], v[16:19]
    v_mfma_f32_16x16x32_bf16 v[20:23], a[124:127], v[44:47], v[20:23]
    buffer_load_dwordx4 a[28:31], v3, s[12:15], s42 offen offset:1792
    v_mfma_f32_16x16x32_bf16 v[24:27], a[248:251], v[44:47], v[24:27]
    v_mfma_f32_16x16x32_bf16 v[28:31], a[252:255], v[44:47], v[28:31]
    v_mov_b32 v40, 0
    v_mov_b32 v41, 0
    v_mov_b32 v42, 0
    v_mov_b32 v43, 0
    v_mov_b32 v44, 0
    v_mov_b32 v45, 0
    v_mov_b32 v46, 0
    v_mov_b32 v47, 0
    v_add_f32_dpp v8, v17, v16 quad_perm:[1,1,3,3] row_mask:0xf bank_mask:0xf
    v_add_f32_dpp v9, v19, v18 quad_perm:[1,1,3,3] row_mask:0xf bank_mask:0xf
    v_add_f32_dpp v10, v21, v20 quad_perm:[1,1,3,3] row_mask:0xf bank_mask:0xf
    v_add_f32_dpp v11, v23, v22 quad_perm:[1,1,3,3] row_mask:0xf bank_mask:0xf
    v_add_f32_dpp v12, v25, v24 quad_perm:[1,1,3,3] row_mask:0xf bank_mask:0xf
    v_add_f32_dpp v13, v27, v26 quad_perm:[1,1,3,3] row_mask:0xf bank_mask:0xf
    v_add_f32_dpp v14, v29, v28 quad_perm:[1,1,3,3] row_mask:0xf bank_mask:0xf
    v_add_f32_dpp v15, v31, v30 quad_perm:[1,1,3,3] row_mask:0xf bank_mask:0xf
    v_max3_f32 v60, v8, v9, v10
    v_max3_f32 v60, v60, v11, v12
    v_max3_f32 v60, v60, v13, v14
    v_max_f32 v60, v60, v15
    v_mov_b32 v48, 0
    v_mov_b32 v49, 0
    v_max_f32_dpp v60, v60, v60 row_ror:4 row_mask:0xf bank_mask:0xf
    v_mov_b32 v50, 0
    v_mov_b32 v51, 0
    v_max_f32_dpp v60, v60, v60 row_ror:8 row_mask:0xf bank_mask:0xf
    v_mov_b32 v63, v60
    v_mov_b32 v52, 0
    v_mov_b32 v53, 0
    v_permlane16_swap_b32 v60, v63
    v_max_f32 v60, v60, v63
    v_mov_b32 v63, v60
    v_mov_b32 v54, 0
    v_mov_b32 v55, 0
    v_permlane32_swap_b32 v60, v63
    v_max_f32 v60, v60, v63
    v_mul_f32 v60, s57, v60
    v_sub_f32 v60, 0, v60
    v_fma_f32 v8, v8, s57, v60
    v_fma_f32 v9, v9, s57, v60
    v_fma_f32 v10, v10, s57, v60
    v_fma_f32 v11, v11, s57, v60
    v_fma_f32 v12, v12, s57, v60
    v_fma_f32 v13, v13, s57, v60
    v_fma_f32 v14, v14, s57, v60
    v_fma_f32 v15, v15, s57, v60
    v_exp_f32 v8, v8
    v_exp_f32 v9, v9
    v_exp_f32 v10, v10
    v_exp_f32 v11, v11
    v_exp_f32 v12, v12
    v_exp_f32 v13, v13
    v_exp_f32 v14, v14
    v_exp_f32 v15, v15
    v_mov_b32 v56, 0
    v_mov_b32 v57, 0
    v_mov_b32 v58, 0
    v_mov_b32 v59, 0
    v_add_f32 v61, v8, v9
    v_add_f32 v63, v10, v11
    v_add_f32 v61, v61, v12
    v_add_f32 v63, v63, v13
    v_add_f32 v61, v61, v14
    v_add_f32 v63, v63, v15
    v_cvt_pk_bf16_f32 v8, v8, v8
    v_cvt_pk_bf16_f32 v9, v9, v9
    v_cvt_pk_bf16_f32 v10, v10, v10
    v_cvt_pk_bf16_f32 v11, v11, v11
    v_cvt_pk_bf16_f32 v12, v12, v12
    v_cvt_pk_bf16_f32 v13, v13, v13
    v_cvt_pk_bf16_f32 v14, v14, v14
    v_cvt_pk_bf16_f32 v15, v15, v15
    v_add_f32 v61, v61, v63
    v_and_b32_dpp v8, v8, v62 quad_perm:[0,0,2,2] row_mask:0xf bank_mask:0xf
    v_and_b32_dpp v9, v9, v62 quad_perm:[0,0,2,2] row_mask:0xf bank_mask:0xf
    v_and_b32_dpp v10, v10, v62 quad_perm:[0,0,2,2] row_mask:0xf bank_mask:0xf
    v_and_b32_dpp v11, v11, v62 quad_perm:[0,0,2,2] row_mask:0xf bank_mask:0xf
    v_and_b32_dpp v12, v12, v62 quad_perm:[0,0,2,2] row_mask:0xf bank_mask:0xf
    v_and_b32_dpp v13, v13, v62 quad_perm:[0,0,2,2] row_mask:0xf bank_mask:0xf
    v_and_b32_dpp v14, v14, v62 quad_perm:[0,0,2,2] row_mask:0xf bank_mask:0xf
    v_and_b32_dpp v15, v15, v62 quad_perm:[0,0,2,2] row_mask:0xf bank_mask:0xf
    v_mov_b32_dpp v48, v8 quad_perm:[0,1,2,3] row_mask:0xf bank_mask:0x1
    v_mov_b32_dpp v49, v8 row_shr:4 row_mask:0xf bank_mask:0x2
    v_mov_b32_dpp v50, v8 row_shr:8 row_mask:0xf bank_mask:0x4
    v_mov_b32_dpp v51, v8 row_shr:12 row_mask:0xf bank_mask:0x8
    v_mov_b32_dpp v52, v9 quad_perm:[0,1,2,3] row_mask:0xf bank_mask:0x1
    v_mov_b32_dpp v53, v9 row_shr:4 row_mask:0xf bank_mask:0x2
    v_mov_b32_dpp v54, v9 row_shr:8 row_mask:0xf bank_mask:0x4
    v_mov_b32_dpp v55, v9 row_shr:12 row_mask:0xf bank_mask:0x8
    v_mfma_f32_16x16x32_bf16 v[40:43], v[64:67], v[48:51], v[40:43]
    v_mov_b32_dpp v56, v10 quad_perm:[0,1,2,3] row_mask:0xf bank_mask:0x1
    v_mov_b32_dpp v57, v10 row_shr:4 row_mask:0xf bank_mask:0x2
    v_mfma_f32_16x16x32_bf16 v[44:47], v[68:71], v[48:51], v[44:47]
    v_mov_b32_dpp v58, v10 row_shr:8 row_mask:0xf bank_mask:0x4
    v_mov_b32_dpp v59, v10 row_shr:12 row_mask:0xf bank_mask:0x8
    buffer_load_dwordx4 a[32:35], v3, s[12:15], s43 offen offset:0
    v_mfma_f32_16x16x32_bf16 v[40:43], v[72:75], v[52:55], v[40:43]
    v_mov_b32_dpp v48, v11 quad_perm:[0,1,2,3] row_mask:0xf bank_mask:0x1
    v_mov_b32_dpp v49, v11 row_shr:4 row_mask:0xf bank_mask:0x2
    v_mfma_f32_16x16x32_bf16 v[44:47], v[76:79], v[52:55], v[44:47]
    v_mov_b32_dpp v50, v11 row_shr:8 row_mask:0xf bank_mask:0x4
    v_mov_b32_dpp v51, v11 row_shr:12 row_mask:0xf bank_mask:0x8
    v_mfma_f32_16x16x32_bf16 v[40:43], v[80:83], v[56:59], v[40:43]
    v_mov_b32_dpp v52, v8 row_shl:4 row_mask:0xf bank_mask:0x1
    v_mov_b32_dpp v53, v8 quad_perm:[0,1,2,3] row_mask:0xf bank_mask:0x2
    v_mfma_f32_16x16x32_bf16 v[44:47], v[84:87], v[56:59], v[44:47]
    v_mov_b32_dpp v54, v8 row_shr:4 row_mask:0xf bank_mask:0x4
    v_mov_b32_dpp v55, v8 row_shr:8 row_mask:0xf bank_mask:0x8
    buffer_load_dwordx4 a[36:39], v3, s[12:15], s43 offen offset:256
    v_mfma_f32_16x16x32_bf16 v[40:43], v[88:91], v[48:51], v[40:43]
    v_mov_b32_dpp v56, v9 row_shl:4 row_mask:0xf bank_mask:0x1
    v_mov_b32_dpp v57, v9 quad_perm:[0,1,2,3] row_mask:0xf bank_mask:0x2
    v_mfma_f32_16x16x32_bf16 v[44:47], v[92:95], v[48:51], v[44:47]
    v_mov_b32_dpp v58, v9 row_shr:4 row_mask:0xf bank_mask:0x4
    v_mov_b32_dpp v59, v9 row_shr:8 row_mask:0xf bank_mask:0x8
    v_mfma_f32_16x16x32_bf16 v[40:43], v[96:99], v[52:55], v[40:43]
    v_mov_b32_dpp v48, v10 row_shl:4 row_mask:0xf bank_mask:0x1
    v_mov_b32_dpp v49, v10 quad_perm:[0,1,2,3] row_mask:0xf bank_mask:0x2
    v_mfma_f32_16x16x32_bf16 v[44:47], v[100:103], v[52:55], v[44:47]
    v_mov_b32_dpp v50, v10 row_shr:4 row_mask:0xf bank_mask:0x4
    v_mov_b32_dpp v51, v10 row_shr:8 row_mask:0xf bank_mask:0x8
    buffer_load_dwordx4 a[40:43], v3, s[12:15], s43 offen offset:512
    v_mfma_f32_16x16x32_bf16 v[40:43], v[104:107], v[56:59], v[40:43]
    v_mov_b32_dpp v52, v11 row_shl:4 row_mask:0xf bank_mask:0x1
    v_mov_b32_dpp v53, v11 quad_perm:[0,1,2,3] row_mask:0xf bank_mask:0x2
    v_mfma_f32_16x16x32_bf16 v[44:47], v[108:111], v[56:59], v[44:47]
    v_mov_b32_dpp v54, v11 row_shr:4 row_mask:0xf bank_mask:0x4
    v_mov_b32_dpp v55, v11 row_shr:8 row_mask:0xf bank_mask:0x8
    v_mfma_f32_16x16x32_bf16 v[40:43], v[112:115], v[48:51], v[40:43]
    v_mov_b32_dpp v56, v8 row_shl:8 row_mask:0xf bank_mask:0x1
    v_mov_b32_dpp v57, v8 row_shl:4 row_mask:0xf bank_mask:0x2
    v_mfma_f32_16x16x32_bf16 v[44:47], v[116:119], v[48:51], v[44:47]
    v_mov_b32_dpp v58, v8 quad_perm:[0,1,2,3] row_mask:0xf bank_mask:0x4
    v_mov_b32_dpp v59, v8 row_shr:4 row_mask:0xf bank_mask:0x8
    buffer_load_dwordx4 a[44:47], v3, s[12:15], s43 offen offset:768
    v_mfma_f32_16x16x32_bf16 v[40:43], v[120:123], v[52:55], v[40:43]
    v_mov_b32_dpp v48, v9 row_shl:8 row_mask:0xf bank_mask:0x1
    v_mov_b32_dpp v49, v9 row_shl:4 row_mask:0xf bank_mask:0x2
    v_mfma_f32_16x16x32_bf16 v[44:47], v[124:127], v[52:55], v[44:47]
    v_mov_b32_dpp v50, v9 quad_perm:[0,1,2,3] row_mask:0xf bank_mask:0x4
    v_mov_b32_dpp v51, v9 row_shr:4 row_mask:0xf bank_mask:0x8
    v_mfma_f32_16x16x32_bf16 v[40:43], v[128:131], v[56:59], v[40:43]
    v_mov_b32_dpp v52, v10 row_shl:8 row_mask:0xf bank_mask:0x1
    v_mov_b32_dpp v53, v10 row_shl:4 row_mask:0xf bank_mask:0x2
    v_mfma_f32_16x16x32_bf16 v[44:47], v[132:135], v[56:59], v[44:47]
    v_mov_b32_dpp v54, v10 quad_perm:[0,1,2,3] row_mask:0xf bank_mask:0x4
    v_mov_b32_dpp v55, v10 row_shr:4 row_mask:0xf bank_mask:0x8
    buffer_load_dwordx4 a[48:51], v3, s[12:15], s43 offen offset:1024
    v_mfma_f32_16x16x32_bf16 v[40:43], v[136:139], v[48:51], v[40:43]
    v_mov_b32_dpp v56, v11 row_shl:8 row_mask:0xf bank_mask:0x1
    v_mov_b32_dpp v57, v11 row_shl:4 row_mask:0xf bank_mask:0x2
    v_mfma_f32_16x16x32_bf16 v[44:47], v[140:143], v[48:51], v[44:47]
    v_mov_b32_dpp v58, v11 quad_perm:[0,1,2,3] row_mask:0xf bank_mask:0x4
    v_mov_b32_dpp v59, v11 row_shr:4 row_mask:0xf bank_mask:0x8
    v_add_u32 v23, s66, v1
    ds_read_b128 v[96:99], v23 offset:8192
    ds_read_b128 v[100:103], v23 offset:9216
    v_mfma_f32_16x16x32_bf16 v[40:43], v[144:147], v[52:55], v[40:43]
    v_mov_b32_dpp v48, v8 row_shl:12 row_mask:0xf bank_mask:0x1
    v_mov_b32_dpp v49, v8 row_shl:8 row_mask:0xf bank_mask:0x2
    v_mfma_f32_16x16x32_bf16 v[44:47], v[148:151], v[52:55], v[44:47]
    v_mov_b32_dpp v50, v8 row_shl:4 row_mask:0xf bank_mask:0x4
    v_mov_b32_dpp v51, v8 quad_perm:[0,1,2,3] row_mask:0xf bank_mask:0x8
    buffer_load_dwordx4 a[52:55], v3, s[12:15], s43 offen offset:1280
    v_mfma_f32_16x16x32_bf16 v[40:43], v[152:155], v[56:59], v[40:43]
    v_mov_b32_dpp v52, v9 row_shl:12 row_mask:0xf bank_mask:0x1
    v_mov_b32_dpp v53, v9 row_shl:8 row_mask:0xf bank_mask:0x2
    v_mfma_f32_16x16x32_bf16 v[44:47], v[156:159], v[56:59], v[44:47]
    v_mov_b32_dpp v54, v9 row_shl:4 row_mask:0xf bank_mask:0x4
    v_mov_b32_dpp v55, v9 quad_perm:[0,1,2,3] row_mask:0xf bank_mask:0x8
    v_mfma_f32_16x16x32_bf16 v[40:43], v[160:163], v[48:51], v[40:43]
    v_mov_b32_dpp v56, v10 row_shl:12 row_mask:0xf bank_mask:0x1
    v_mov_b32_dpp v57, v10 row_shl:8 row_mask:0xf bank_mask:0x2
    v_mfma_f32_16x16x32_bf16 v[44:47], v[164:167], v[48:51], v[44:47]
    v_mov_b32_dpp v58, v10 row_shl:4 row_mask:0xf bank_mask:0x4
    v_mov_b32_dpp v59, v10 quad_perm:[0,1,2,3] row_mask:0xf bank_mask:0x8
    buffer_load_dwordx4 a[56:59], v3, s[12:15], s43 offen offset:1536
    v_mfma_f32_16x16x32_bf16 v[40:43], v[168:171], v[52:55], v[40:43]
    v_mov_b32_dpp v48, v11 row_shl:12 row_mask:0xf bank_mask:0x1
    v_mov_b32_dpp v49, v11 row_shl:8 row_mask:0xf bank_mask:0x2
    v_mfma_f32_16x16x32_bf16 v[44:47], v[172:175], v[52:55], v[44:47]
    v_mov_b32_dpp v50, v11 row_shl:4 row_mask:0xf bank_mask:0x4
    v_mov_b32_dpp v51, v11 quad_perm:[0,1,2,3] row_mask:0xf bank_mask:0x8
    v_mfma_f32_16x16x32_bf16 v[40:43], v[176:179], v[56:59], v[40:43]
    v_mov_b32_dpp v52, v12 quad_perm:[0,1,2,3] row_mask:0xf bank_mask:0x1
    v_mov_b32_dpp v53, v12 row_shr:4 row_mask:0xf bank_mask:0x2
    v_mfma_f32_16x16x32_bf16 v[44:47], v[180:183], v[56:59], v[44:47]
    v_mov_b32_dpp v54, v12 row_shr:8 row_mask:0xf bank_mask:0x4
    v_mov_b32_dpp v55, v12 row_shr:12 row_mask:0xf bank_mask:0x8
    buffer_load_dwordx4 a[60:63], v3, s[12:15], s43 offen offset:1792
    v_mfma_f32_16x16x32_bf16 v[40:43], v[184:187], v[48:51], v[40:43]
    v_mov_b32_dpp v56, v13 quad_perm:[0,1,2,3] row_mask:0xf bank_mask:0x1
    v_mov_b32_dpp v57, v13 row_shr:4 row_mask:0xf bank_mask:0x2
    v_mfma_f32_16x16x32_bf16 v[44:47], v[188:191], v[48:51], v[44:47]
    v_mov_b32_dpp v58, v13 row_shr:8 row_mask:0xf bank_mask:0x4
    v_mov_b32_dpp v59, v13 row_shr:12 row_mask:0xf bank_mask:0x8
    v_mfma_f32_16x16x32_bf16 v[40:43], v[192:195], v[52:55], v[40:43]
    v_mov_b32_dpp v48, v14 quad_perm:[0,1,2,3] row_mask:0xf bank_mask:0x1
    v_mov_b32_dpp v49, v14 row_shr:4 row_mask:0xf bank_mask:0x2
    v_mfma_f32_16x16x32_bf16 v[44:47], v[196:199], v[52:55], v[44:47]
    v_mov_b32_dpp v50, v14 row_shr:8 row_mask:0xf bank_mask:0x4
    v_mov_b32_dpp v51, v14 row_shr:12 row_mask:0xf bank_mask:0x8
    v_mfma_f32_16x16x32_bf16 v[40:43], v[200:203], v[56:59], v[40:43]
    v_mov_b32_dpp v52, v15 quad_perm:[0,1,2,3] row_mask:0xf bank_mask:0x1
    v_mov_b32_dpp v53, v15 row_shr:4 row_mask:0xf bank_mask:0x2
    v_mfma_f32_16x16x32_bf16 v[44:47], v[204:207], v[56:59], v[44:47]
    v_mov_b32_dpp v54, v15 row_shr:8 row_mask:0xf bank_mask:0x4
    v_mov_b32_dpp v55, v15 row_shr:12 row_mask:0xf bank_mask:0x8
    v_bfe_u32 v16, v1, 4, 3
    v_bfe_u32 v17, v1, 7, 1
    v_lshl_add_u32 v16, v17, 5, v16
    v_mfma_f32_16x16x32_bf16 v[40:43], v[208:211], v[48:51], v[40:43]
    v_mov_b32_dpp v56, v12 row_shl:4 row_mask:0xf bank_mask:0x1
    v_mov_b32_dpp v57, v12 quad_perm:[0,1,2,3] row_mask:0xf bank_mask:0x2
    v_mfma_f32_16x16x32_bf16 v[44:47], v[212:215], v[48:51], v[44:47]
    v_mov_b32_dpp v58, v12 row_shr:4 row_mask:0xf bank_mask:0x4
    v_mov_b32_dpp v59, v12 row_shr:8 row_mask:0xf bank_mask:0x8
    v_mul_u32_u24 v16, 896, v16
    v_bfe_u32 v17, v1, 8, 2
    v_lshl_add_u32 v16, v17, 4, v16
    v_mfma_f32_16x16x32_bf16 v[40:43], v[216:219], v[52:55], v[40:43]
    v_mov_b32_dpp v48, v13 row_shl:4 row_mask:0xf bank_mask:0x1
    v_mov_b32_dpp v49, v13 quad_perm:[0,1,2,3] row_mask:0xf bank_mask:0x2
    v_mfma_f32_16x16x32_bf16 v[44:47], v[220:223], v[52:55], v[44:47]
    v_mov_b32_dpp v50, v13 row_shr:4 row_mask:0xf bank_mask:0x4
    v_mov_b32_dpp v51, v13 row_shr:8 row_mask:0xf bank_mask:0x8
    buffer_load_dwordx4 v[24:27], v16, s[32:35], s82 offen
    v_mfma_f32_16x16x32_bf16 v[40:43], v[224:227], v[56:59], v[40:43]
    v_mov_b32_dpp v52, v14 row_shl:4 row_mask:0xf bank_mask:0x1
    v_mov_b32_dpp v53, v14 quad_perm:[0,1,2,3] row_mask:0xf bank_mask:0x2
    v_mfma_f32_16x16x32_bf16 v[44:47], v[228:231], v[56:59], v[44:47]
    v_mov_b32_dpp v54, v14 row_shr:4 row_mask:0xf bank_mask:0x4
    v_mov_b32_dpp v55, v14 row_shr:8 row_mask:0xf bank_mask:0x8
    buffer_load_dwordx4 v[28:31], v16, s[32:35], s83 offen
    v_mfma_f32_16x16x32_bf16 v[40:43], v[232:235], v[48:51], v[40:43]
    v_mov_b32_dpp v56, v15 row_shl:4 row_mask:0xf bank_mask:0x1
    v_mov_b32_dpp v57, v15 quad_perm:[0,1,2,3] row_mask:0xf bank_mask:0x2
    v_mfma_f32_16x16x32_bf16 v[44:47], v[236:239], v[48:51], v[44:47]
    v_mov_b32_dpp v58, v15 row_shr:4 row_mask:0xf bank_mask:0x4
    v_mov_b32_dpp v59, v15 row_shr:8 row_mask:0xf bank_mask:0x8
    buffer_load_dwordx4 v[32:35], v16, s[32:35], s84 offen
    v_mfma_f32_16x16x32_bf16 v[40:43], v[240:243], v[52:55], v[40:43]
    v_mov_b32_dpp v48, v12 row_shl:8 row_mask:0xf bank_mask:0x1
    v_mov_b32_dpp v49, v12 row_shl:4 row_mask:0xf bank_mask:0x2
    v_mfma_f32_16x16x32_bf16 v[44:47], v[244:247], v[52:55], v[44:47]
    v_mov_b32_dpp v50, v12 quad_perm:[0,1,2,3] row_mask:0xf bank_mask:0x4
    v_mov_b32_dpp v51, v12 row_shr:4 row_mask:0xf bank_mask:0x8
    buffer_load_dwordx4 v[36:39], v16, s[32:35], s85 offen
    v_mfma_f32_16x16x32_bf16 v[40:43], v[248:251], v[56:59], v[40:43]
    v_mov_b32_dpp v52, v13 row_shl:8 row_mask:0xf bank_mask:0x1
    v_mov_b32_dpp v53, v13 row_shl:4 row_mask:0xf bank_mask:0x2
    v_mfma_f32_16x16x32_bf16 v[44:47], v[252:255], v[56:59], v[44:47]
    v_mov_b32_dpp v54, v13 quad_perm:[0,1,2,3] row_mask:0xf bank_mask:0x4
    v_mov_b32_dpp v55, v13 row_shr:4 row_mask:0xf bank_mask:0x8
    s_waitcnt vmcnt(4) lgkmcnt(0)
    v_mfma_f32_16x16x32_bf16 v[40:43], a[0:3], v[48:51], v[40:43]
    v_mov_b32_dpp v56, v14 row_shl:8 row_mask:0xf bank_mask:0x1
    v_mov_b32_dpp v57, v14 row_shl:4 row_mask:0xf bank_mask:0x2
    v_mfma_f32_16x16x32_bf16 v[44:47], a[4:7], v[48:51], v[44:47]
    v_mov_b32_dpp v58, v14 quad_perm:[0,1,2,3] row_mask:0xf bank_mask:0x4
    v_mov_b32_dpp v59, v14 row_shr:4 row_mask:0xf bank_mask:0x8
    v_mfma_f32_16x16x32_bf16 v[40:43], a[8:11], v[52:55], v[40:43]
    v_mov_b32_dpp v48, v15 row_shl:8 row_mask:0xf bank_mask:0x1
    v_mov_b32_dpp v49, v15 row_shl:4 row_mask:0xf bank_mask:0x2
    v_mfma_f32_16x16x32_bf16 v[44:47], a[12:15], v[52:55], v[44:47]
    v_mov_b32_dpp v50, v15 quad_perm:[0,1,2,3] row_mask:0xf bank_mask:0x4
    v_mov_b32_dpp v51, v15 row_shr:4 row_mask:0xf bank_mask:0x8
    v_mfma_f32_16x16x32_bf16 v[40:43], a[16:19], v[56:59], v[40:43]
    v_mov_b32_dpp v52, v12 row_shl:12 row_mask:0xf bank_mask:0x1
    v_mov_b32_dpp v53, v12 row_shl:8 row_mask:0xf bank_mask:0x2
    v_mfma_f32_16x16x32_bf16 v[44:47], a[20:23], v[56:59], v[44:47]
    v_mov_b32_dpp v54, v12 row_shl:4 row_mask:0xf bank_mask:0x4
    v_mov_b32_dpp v55, v12 quad_perm:[0,1,2,3] row_mask:0xf bank_mask:0x8
    v_mfma_f32_16x16x32_bf16 v[40:43], a[24:27], v[48:51], v[40:43]
    v_mov_b32_dpp v56, v13 row_shl:12 row_mask:0xf bank_mask:0x1
    v_mov_b32_dpp v57, v13 row_shl:8 row_mask:0xf bank_mask:0x2
    v_mfma_f32_16x16x32_bf16 v[44:47], a[28:31], v[48:51], v[44:47]
    v_mov_b32_dpp v58, v13 row_shl:4 row_mask:0xf bank_mask:0x4
    v_mov_b32_dpp v59, v13 quad_perm:[0,1,2,3] row_mask:0xf bank_mask:0x8
    v_mfma_f32_16x16x32_bf16 v[40:43], a[32:35], v[52:55], v[40:43]
    v_mov_b32_dpp v48, v14 row_shl:12 row_mask:0xf bank_mask:0x1
    v_mov_b32_dpp v49, v14 row_shl:8 row_mask:0xf bank_mask:0x2
    v_mfma_f32_16x16x32_bf16 v[44:47], a[36:39], v[52:55], v[44:47]
    v_mov_b32_dpp v50, v14 row_shl:4 row_mask:0xf bank_mask:0x4
    v_mov_b32_dpp v51, v14 quad_perm:[0,1,2,3] row_mask:0xf bank_mask:0x8
    v_mfma_f32_16x16x32_bf16 v[40:43], a[40:43], v[56:59], v[40:43]
    v_mov_b32_dpp v52, v15 row_shl:12 row_mask:0xf bank_mask:0x1
    v_mov_b32_dpp v53, v15 row_shl:8 row_mask:0xf bank_mask:0x2
    v_mfma_f32_16x16x32_bf16 v[44:47], a[44:47], v[56:59], v[44:47]
    v_mov_b32_dpp v54, v15 row_shl:4 row_mask:0xf bank_mask:0x4
    v_mov_b32_dpp v55, v15 quad_perm:[0,1,2,3] row_mask:0xf bank_mask:0x8
    v_mfma_f32_16x16x32_bf16 v[40:43], a[48:51], v[48:51], v[40:43]
    v_mfma_f32_16x16x32_bf16 v[44:47], a[52:55], v[48:51], v[44:47]
    v_mfma_f32_16x16x32_bf16 v[40:43], a[56:59], v[52:55], v[40:43]
    v_mfma_f32_16x16x32_bf16 v[44:47], a[60:63], v[52:55], v[44:47]
.Lchain:
    v_add_f32_dpp v61, v61, v61 row_ror:4 row_mask:0xf bank_mask:0xf
    s_add_u32 s56, s66, 8192
    v_add_u32 v58, s56, v1
    v_add_f32_dpp v61, v61, v61 row_ror:8 row_mask:0xf bank_mask:0xf
    v_bfe_u32 v11, v1, 5, 1
    v_mov_b32 v63, v61
    v_lshlrev_b32 v11, 5, v11
    s_lshl_b32 s56, s3, 3
    v_permlane16_swap_b32 v61, v63
    ds_write_b128 v58, v[40:43]
    ds_write_b128 v58, v[44:47] offset:1024
    v_add_f32 v61, v61, v63
    v_mov_b32 v63, v61
    s_add_u32 s56, s56, 159744
    v_add_u32 v11, s56, v11
    v_permlane32_swap_b32 v61, v63
    v_add_f32 v61, v61, v63
    s_mov_b64 exec, 5
    ds_write_b64 v11, v[60:61]
    s_mov_b64 exec, -1
    v_lshlrev_b32 v56, 3, v0
    v_add_u32 v56, 73728, v56
    v_bfe_u32 v10, v0, 2, 1
    v_lshlrev_b32 v11, 5, v10
    v_add_u32 v11, 159744, v11
    s_waitcnt lgkmcnt(0)
    s_barrier
    ds_read_b128 v[16:19], v11
    ds_read_b128 v[20:23], v11 offset:16
    ds_read_b64 v[48:49], v56
    ds_read_b64 v[50:51], v56 offset:16384
    ds_read_b64 v[52:53], v56 offset:32768
    ds_read_b64 v[54:55], v56 offset:49152
    v_bfe_u32 v57, v0, 1, 1
    v_bfe_u32 v8, v0, 3, 2
    v_lshl_add_u32 v57, v8, 1, v57
    v_lshrrev_b32 v8, 5, v0
    v_lshlrev_b32 v9, 4, v57
    v_lshl_add_u32 v9, v8, 7, v9
    v_lshl_add_u32 v9, v10, 10, v9
    v_and_b32 v57, 3, v57
    v_lshlrev_b32 v57, 3, v57
    v_bfe_u32 v57, s90, v57, 8
    v_mov_b32 v8, 0xff
    s_sub_u32 s56, s70, s69
    v_lshl_add_u32 v10, v10, 9, s56
    s_cmp_eq_u32 s3, 0
    s_cselect_b32 s60, 0x22, 0
    s_or_b32 s60, s60, 0x55555555
    s_waitcnt lgkmcnt(4)
    v_min3_f32 v12, v16, v18, v20
    v_min_f32 v12, v12, v22
    v_sub_f32 v16, v12, v16
    v_sub_f32 v18, v12, v18
    v_sub_f32 v20, v12, v20
    v_sub_f32 v22, v12, v22
    v_exp_f32 v16, v16
    v_exp_f32 v18, v18
    v_exp_f32 v20, v20
    v_exp_f32 v22, v22
    s_waitcnt lgkmcnt(0)
    v_mul_f32 v48, v48, v16
    v_mul_f32 v49, v49, v16
    v_fmac_f32 v48, v50, v18
    v_fmac_f32 v49, v51, v18
    v_fmac_f32 v48, v52, v20
    v_fmac_f32 v49, v53, v20
    v_fmac_f32 v48, v54, v22
    v_fmac_f32 v49, v55, v22
    v_mul_f32 v13, v16, v17
    v_fmac_f32 v13, v18, v19
    v_mov_b32_dpp v50, v48 quad_perm:[1,1,3,3] row_mask:0xf bank_mask:0xf
    v_mov_b32_dpp v51, v49 quad_perm:[1,1,3,3] row_mask:0xf bank_mask:0xf
    v_bfi_b32 v48, v8, v57, v48
    s_mov_b64 exec, 0x22
    v_fmac_f32 v13, v20, v21
    v_fma_f32 v49, v22, v23, v13
    v_mov_b32 v48, v12
    v_mov_b32 v50, s90
    v_mov_b32 v9, v10
    s_cmp_eq_u32 s58, 1
    s_mov_b32 exec_lo, s60
    s_mov_b32 exec_hi, 0x55555555
    s_cbranch_scc0 .ss7
    buffer_store_dwordx4 v[48:51], v9, s[24:27], s69 offen
.sb8:
    s_mov_b64 exec, -1
    s_cmp_ge_u32 s5, 28
    s_cbranch_scc1 .Lno_s1
    v_bfe_u32 v62, v1, 8, 2
    v_lshlrev_b32 v63, 7, v62
    v_and_b32 v61, 0x70, v1
    v_add_u32 v63, v63, v61
    v_lshlrev_b32 v62, 14, v62
    v_and_b32 v61, 0xf0, v1
    v_add_u32 v62, v62, v61
    buffer_load_dwordx3 v[56:58], v63, s[24:27], s71 offen sc1
    buffer_load_dwordx4 v[8:11], v62, s[24:27], s78 offen offset:0 sc1
    buffer_load_dwordx4 v[12:15], v62, s[24:27], s78 offen offset:2048 sc1
    buffer_load_dwordx4 v[16:19], v62, s[24:27], s79 offen offset:0 sc1
    buffer_load_dwordx4 v[20:23], v62, s[24:27], s79 offen offset:2048 sc1
    buffer_load_dwordx4 v[40:43], v62, s[24:27], s80 offen offset:0 sc1
    buffer_load_dwordx4 v[44:47], v62, s[24:27], s80 offen offset:2048 sc1
    buffer_load_dwordx4 v[4:7], v62, s[24:27], s81 offen offset:0 sc1
    buffer_load_dwordx4 v[52:55], v62, s[24:27], s81 offen offset:2048 sc1
    v_bfe_u32 v61, v1, 4, 2
    v_lshlrev_b32 v61, 3, v61
    v_bfe_u32 v61, s90, v61, 8
    s_waitcnt vmcnt(9)
    v_perm_b32 v59, v28, v24, s6
    v_perm_b32 v24, v28, v24, s7
    v_perm_b32 v28, v29, v25, s6
    v_perm_b32 v25, v29, v25, s7
    v_perm_b32 v29, v30, v26, s6
    v_perm_b32 v26, v30, v26, s7
    v_perm_b32 v30, v31, v27, s6
    v_perm_b32 v27, v31, v27, s7
    v_perm_b32 v31, v36, v32, s6
    v_perm_b32 v32, v36, v32, s7
    v_perm_b32 v36, v37, v33, s6
    v_perm_b32 v33, v37, v33, s7
    v_perm_b32 v37, v38, v34, s6
    v_perm_b32 v34, v38, v34, s7
    v_perm_b32 v38, v39, v35, s6
    v_perm_b32 v35, v39, v35, s7
    s_mov_b64 s[40:41], -1
.pw11:
    s_waitcnt vmcnt(8)
    v_min_f32_dpp v39, v56, v56 row_ror:1 row_mask:0xf bank_mask:0xf
    v_and_b32 v50, 0x70, v1
    v_add_u32 v51, 160896, v50
    v_min_f32_dpp v39, v39, v39 row_ror:2 row_mask:0xf bank_mask:0xf
    v_lshrrev_b32 v49, 7, v1
    v_lshl_add_u32 v50, v49, 15, v50
    v_min_f32_dpp v39, v39, v39 row_ror:4 row_mask:0xf bank_mask:0xf
    v_mov_b32 v49, v39
    s_nop 1
    v_permlane16_swap_b32 v39, v49
    v_min_f32 v39, v39, v49
    v_mov_b32 v49, v39
    s_nop 1
    v_permlane32_swap_b32 v39, v49
    v_min_f32 v39, v39, v49
    v_sub_f32 v39, v39, v56
    v_exp_f32 v39, v39
    s_nop 0
    v_mul_f32 v48, v39, v57
    s_mov_b64 exec, s[40:41]
    s_waitcnt vmcnt(0)
    v_xor_b32 v8, v61, v8
    v_xor_b32 v12, v61, v12
    v_xor_b32 v16, v61, v16
    v_xor_b32 v20, v61, v20
    v_xor_b32 v40, v61, v40
    v_xor_b32 v44, v61, v44
    v_xor_b32 v4, v61, v4
    v_xor_b32 v52, v61, v52
    v_or3_b32 v60, v8, v12, v16
    v_or3_b32 v60, v60, v20, v40
    v_or3_b32 v60, v60, v44, v4
    v_or_b32 v60, v60, v52
    v_and_b32 v60, 0xff, v60
    v_xor_b32 v58, s90, v58
    v_or_b32 v60, v60, v58
    v_cmp_ne_u32 vcc, 0, v60
    s_cbranch_vccnz .pr9
.pd10:
    s_mov_b64 exec, -1
    v_mul_f32_dpp v8, v39, v8 row_newbcast:0 row_mask:0xf bank_mask:0xf
    v_mul_f32_dpp v10, v39, v10 row_newbcast:0 row_mask:0xf bank_mask:0xf
    v_mul_f32_dpp v9, v39, v9 row_newbcast:0 row_mask:0xf bank_mask:0xf
    v_mul_f32_dpp v11, v39, v11 row_newbcast:0 row_mask:0xf bank_mask:0xf
    v_add_f32_dpp v48, v48, v48 row_ror:1 row_mask:0xf bank_mask:0xf
    v_fmac_f32_dpp v8, v39, v12 row_newbcast:1 row_mask:0xf bank_mask:0xf
    v_fmac_f32_dpp v10, v39, v14 row_newbcast:1 row_mask:0xf bank_mask:0xf
    v_fmac_f32_dpp v9, v39, v13 row_newbcast:1 row_mask:0xf bank_mask:0xf
    v_fmac_f32_dpp v11, v39, v15 row_newbcast:1 row_mask:0xf bank_mask:0xf
    v_add_f32_dpp v48, v48, v48 row_ror:2 row_mask:0xf bank_mask:0xf
    v_fmac_f32_dpp v8, v39, v16 row_newbcast:2 row_mask:0xf bank_mask:0xf
    v_fmac_f32_dpp v10, v39, v18 row_newbcast:2 row_mask:0xf bank_mask:0xf
    v_fmac_f32_dpp v9, v39, v17 row_newbcast:2 row_mask:0xf bank_mask:0xf
    v_fmac_f32_dpp v11, v39, v19 row_newbcast:2 row_mask:0xf bank_mask:0xf
    v_add_f32_dpp v48, v48, v48 row_ror:4 row_mask:0xf bank_mask:0xf
    v_mov_b32 v49, v48
    v_fmac_f32_dpp v8, v39, v20 row_newbcast:3 row_mask:0xf bank_mask:0xf
    v_fmac_f32_dpp v10, v39, v22 row_newbcast:3 row_mask:0xf bank_mask:0xf
    v_fmac_f32_dpp v9, v39, v21 row_newbcast:3 row_mask:0xf bank_mask:0xf
    v_fmac_f32_dpp v11, v39, v23 row_newbcast:3 row_mask:0xf bank_mask:0xf
    v_permlane16_swap_b32 v48, v49
    v_add_f32 v48, v48, v49
    v_mov_b32 v49, v48
    v_fmac_f32_dpp v8, v39, v40 row_newbcast:4 row_mask:0xf bank_mask:0xf
    v_fmac_f32_dpp v10, v39, v42 row_newbcast:4 row_mask:0xf bank_mask:0xf
    v_fmac_f32_dpp v9, v39, v41 row_newbcast:4 row_mask:0xf bank_mask:0xf
    v_fmac_f32_dpp v11, v39, v43 row_newbcast:4 row_mask:0xf bank_mask:0xf
    v_permlane32_swap_b32 v48, v49
    v_add_f32 v48, v48, v49
    v_fmac_f32_dpp v8, v39, v44 row_newbcast:5 row_mask:0xf bank_mask:0xf
    v_fmac_f32_dpp v10, v39, v46 row_newbcast:5 row_mask:0xf bank_mask:0xf
    v_fmac_f32_dpp v9, v39, v45 row_newbcast:5 row_mask:0xf bank_mask:0xf
    v_fmac_f32_dpp v11, v39, v47 row_newbcast:5 row_mask:0xf bank_mask:0xf
    v_rcp_f32 v48, v48
    v_fmac_f32_dpp v8, v39, v4 row_newbcast:6 row_mask:0xf bank_mask:0xf
    v_fmac_f32_dpp v10, v39, v6 row_newbcast:6 row_mask:0xf bank_mask:0xf
    v_fmac_f32_dpp v9, v39, v5 row_newbcast:6 row_mask:0xf bank_mask:0xf
    v_fmac_f32_dpp v11, v39, v7 row_newbcast:6 row_mask:0xf bank_mask:0xf
    v_fmac_f32_dpp v8, v39, v52 row_newbcast:7 row_mask:0xf bank_mask:0xf
    v_fmac_f32_dpp v10, v39, v54 row_newbcast:7 row_mask:0xf bank_mask:0xf
    v_fmac_f32_dpp v9, v39, v53 row_newbcast:7 row_mask:0xf bank_mask:0xf
    v_fmac_f32_dpp v11, v39, v55 row_newbcast:7 row_mask:0xf bank_mask:0xf
    v_permlane32_swap_b32 v8, v10
    s_lshl_b32 s56, s3, 7
    v_permlane32_swap_b32 v9, v11
    v_add_f32 v8, v8, v10
    v_add_f32 v9, v9, v11
    v_mov_b32 v10, v8
    v_mov_b32 v11, v9
    s_add_u32 s56, s56, 160896
    v_permlane16_swap_b32 v8, v10
    v_permlane16_swap_b32 v9, v11
    v_add_f32 v8, v8, v10
    v_add_f32 v9, v9, v11
    v_mul_f32 v8, v8, v48
    v_mul_f32 v9, v9, v48
    v_cvt_pk_bf16_f32 v8, v8, v9
    v_mov_b32 v9, v8
    v_lshrrev_b32 v49, 6, v1
    v_lshl_add_u32 v49, v49, 3, s56
    v_permlane32_swap_b32 v8, v9
    v_dot2_f32_bf16 v40, v59, v8, 0
    v_dot2_f32_bf16 v41, v24, v8, 0
    v_dot2_f32_bf16 v42, v28, v8, 0
    v_dot2_f32_bf16 v43, v25, v8, 0
    v_dot2_f32_bf16 v44, v29, v8, 0
    v_dot2_f32_bf16 v45, v26, v8, 0
    v_dot2_f32_bf16 v46, v30, v8, 0
    v_dot2_f32_bf16 v47, v27, v8, 0
    v_dot2_f32_bf16 v40, v31, v9, v40
    v_dot2_f32_bf16 v41, v32, v9, v41
    v_dot2_f32_bf16 v42, v36, v9, v42
    v_dot2_f32_bf16 v43, v33, v9, v43
    v_dot2_f32_bf16 v44, v37, v9, v44
    v_dot2_f32_bf16 v45, v34, v9, v45
    v_dot2_f32_bf16 v46, v38, v9, v46
    v_dot2_f32_bf16 v47, v35, v9, v47
    v_add_f32_dpp v40, v40, v40 row_ror:8 row_mask:0xf bank_mask:0x3
    v_add_f32_dpp v41, v41, v41 row_ror:8 row_mask:0xf bank_mask:0x3
    v_add_f32_dpp v42, v42, v42 row_ror:8 row_mask:0xf bank_mask:0x3
    v_add_f32_dpp v43, v43, v43 row_ror:8 row_mask:0xf bank_mask:0x3
    v_add_f32_dpp v40, v44, v44 row_ror:8 row_mask:0xf bank_mask:0xc
    v_add_f32_dpp v41, v45, v45 row_ror:8 row_mask:0xf bank_mask:0xc
    v_add_f32_dpp v42, v46, v46 row_ror:8 row_mask:0xf bank_mask:0xc
    v_add_f32_dpp v43, v47, v47 row_ror:8 row_mask:0xf bank_mask:0xc
    v_add_f32_dpp v40, v40, v40 row_shl:4 row_mask:0xf bank_mask:0x5
    v_add_f32_dpp v41, v41, v41 row_shl:4 row_mask:0xf bank_mask:0x5
    v_add_f32_dpp v40, v42, v42 row_shr:4 row_mask:0xf bank_mask:0xa
    v_add_f32_dpp v41, v43, v43 row_shr:4 row_mask:0xf bank_mask:0xa
    v_mov_b32 v2, 159824
    v_add_f32_dpp v40, v40, v40 quad_perm:[2,3,0,1] row_mask:0xf bank_mask:0xf
    v_add_f32_dpp v41, v41, v41 quad_perm:[2,3,0,1] row_mask:0xf bank_mask:0xf
    s_cmp_lg_u32 s3, 0
    v_add_f32_dpp v40, v40, v40 quad_perm:[1,0,3,2] row_mask:0xf bank_mask:0xf
    v_add_f32_dpp v41, v41, v41 quad_perm:[1,0,3,2] row_mask:0xf bank_mask:0xf
    ds_write_b64 v49, v[40:41]
    s_cbranch_scc1 .Ls1_other
    v_mov_b32 v3, s89
    ds_write_b32 v2, v3
    v_mov_b32 v48, 0xff
    s_cmp_eq_u32 s59, 3
    s_waitcnt lgkmcnt(0)
    s_barrier
    ds_read_b128 v[8:11], v51
    ds_read_b128 v[12:15], v51 offset:128
    ds_read_b128 v[16:19], v51 offset:256
    ds_read_b128 v[20:23], v51 offset:384
    s_cselect_b64 exec, 0xff, -1
    s_waitcnt lgkmcnt(2)
    v_add_f32 v8, v8, v12
    v_add_f32 v9, v9, v13
    v_add_f32 v10, v10, v14
    v_add_f32 v11, v11, v15
    s_waitcnt lgkmcnt(0)
    v_add_f32 v16, v16, v20
    v_add_f32 v17, v17, v21
    v_add_f32 v18, v18, v22
    v_add_f32 v19, v19, v23
    v_add_f32 v8, v8, v16
    v_add_f32 v9, v9, v17
    v_add_f32 v10, v10, v18
    v_add_f32 v11, v11, v19
    v_bfi_b32 v8, v48, v61, v8
    buffer_store_dwordx4 v[8:11], v50, s[24:27], s72 offen sc1
    s_mov_b64 exec, -1
    s_cmp_eq_u32 s59, 3
    s_cbranch_scc1 .Lfin
    s_cmp_lg_u32 s59, 2
    s_cbranch_scc1 .Lprep
    s_call_b64 s[64:65], sub_breg
.Lprep:
    s_bitcmp1_b32 s59, 0
    s_cselect_b32 s32, s44, s46
    s_cselect_b32 s33, s45, s47
    s_cselect_b32 s52, 0, 14336
    s_add_u32 s52, s52, 131072
    s_and_b32 s86, s90, 0xffff
    s_lshr_b32 s87, s90, 16
    s_add_u32 s36, s24, s75
    s_addc_u32 s37, s25, 0
    s_mov_b32 s38, 26624
    v_bfe_u32 v6, v1, 8, 2
    v_mul_u32_u24 v7, 448, v6
    v_mul_u32_u24 v6, 3584, v6
    v_bfe_u32 v4, v1, 4, 4
    v_lshl_add_u32 v6, v4, 3, v6
    v_add_u32 v6, s52, v6
    v_lshl_add_u32 v7, v4, 5, v7
    v_cmp_gt_u32 vcc, 14, v4
    v_mov_b32 v4, 65536
    s_nop 0
    v_cndmask_b32 v7, v4, v7, vcc
    ds_read_b64_tr_b16 v[8:9], v6 offset:0
    ds_read_b64_tr_b16 v[10:11], v6 offset:128
    ds_read_b64_tr_b16 v[12:13], v6 offset:256
    ds_read_b64_tr_b16 v[14:15], v6 offset:384
    ds_read_b64_tr_b16 v[16:17], v6 offset:512
    ds_read_b64_tr_b16 v[18:19], v6 offset:640
    ds_read_b64_tr_b16 v[20:21], v6 offset:768
    ds_read_b64_tr_b16 v[22:23], v6 offset:896
    ds_read_b64_tr_b16 v[24:25], v6 offset:1024
    ds_read_b64_tr_b16 v[26:27], v6 offset:1152
    ds_read_b64_tr_b16 v[28:29], v6 offset:1280
    ds_read_b64_tr_b16 v[30:31], v6 offset:1408
    ds_read_b64_tr_b16 v[32:33], v6 offset:1536
    ds_read_b64_tr_b16 v[34:35], v6 offset:1664
    ds_read_b64_tr_b16 v[36:37], v6 offset:1792
    ds_read_b64_tr_b16 v[38:39], v6 offset:1920
    ds_read_b64_tr_b16 v[56:57], v6 offset:2048
    ds_read_b64_tr_b16 v[58:59], v6 offset:2176
    ds_read_b64_tr_b16 v[60:61], v6 offset:2304
    ds_read_b64_tr_b16 v[62:63], v6 offset:2432
.Ls3:
    buffer_load_dwordx4 v[44:47], v7, s[36:39], 0 offen sc1
    buffer_load_dwordx4 v[48:51], v7, s[36:39], 0 offen offset:16 sc1
    s_mov_b32 exec_lo, 0x3fff3fff
    s_mov_b32 exec_hi, 0x3fff3fff
.pw14:
    s_waitcnt vmcnt(0)
    v_xor_b32 v40, s86, v44
    v_bitop3_b32 v40, v40, v45, s87 bitop3:0xf6
    v_bitop3_b32 v40, v40, v46, s86 bitop3:0xf6
    v_bitop3_b32 v40, v40, v47, s87 bitop3:0xf6
    v_bitop3_b32 v40, v40, v48, s86 bitop3:0xf6
    v_bitop3_b32 v40, v40, v49, s87 bitop3:0xf6
    v_bitop3_b32 v40, v40, v50, s86 bitop3:0xf6
    v_bitop3_b32 v40, v40, v51, s87 bitop3:0xf6
    v_and_b32 v40, 0xffff, v40
    v_cmp_ne_u32 vcc, 0, v40
    s_cbranch_vccnz .pr12
.pd13:
    s_mov_b64 exec, -1
    v_perm_b32 v40, v45, v44, s7
    v_perm_b32 v41, v47, v46, s7
    v_perm_b32 v42, v49, v48, s7
    v_perm_b32 v43, v51, v50, s7
sub_s3b:
    v_mov_b32 v44, s53
    v_mov_b32 v45, s53
    v_mov_b32 v46, s53
    v_mov_b32 v47, s53
    v_mov_b32 v48, s53
    v_mov_b32 v49, s53
    v_mov_b32 v50, s53
    v_mov_b32 v51, s53
    s_waitcnt lgkmcnt(0)
    v_mov_b64_dpp v[44:45], v[40:41] row_newbcast:0 row_mask:0xf bank_mask:0x3
    v_mov_b64_dpp v[46:47], v[42:43] row_newbcast:0 row_mask:0xf bank_mask:0x3
    v_mov_b64_dpp v[48:49], v[40:41] row_newbcast:1 row_mask:0xf bank_mask:0x3
    v_mov_b64_dpp v[50:51], v[42:43] row_newbcast:1 row_mask:0xf bank_mask:0x3
    v_mfma_f32_16x16x32_bf16 v[52:55], v[8:11], v[44:47], 0
    v_dot2_f32_bf16 v2, v40, s53, 0
    v_dot2_f32_bf16 v3, v40, v40, 0
    v_dot2_f32_bf16 v2, v41, s53, v2
    v_dot2_f32_bf16 v3, v41, v41, v3
    v_mov_b64_dpp v[44:45], v[40:41] row_newbcast:2 row_mask:0xf bank_mask:0x3
    v_mov_b64_dpp v[46:47], v[42:43] row_newbcast:2 row_mask:0xf bank_mask:0x3
    v_mfma_f32_16x16x32_bf16 v[52:55], v[12:15], v[48:51], v[52:55]
    ds_read_b64_tr_b16 v[8:9], v6 offset:2560
    ds_read_b64_tr_b16 v[10:11], v6 offset:2688
    v_dot2_f32_bf16 v2, v42, s53, v2
    v_dot2_f32_bf16 v3, v42, v42, v3
    v_dot2_f32_bf16 v2, v43, s53, v2
    v_dot2_f32_bf16 v3, v43, v43, v3
    v_mov_b64_dpp v[48:49], v[40:41] row_newbcast:3 row_mask:0xf bank_mask:0x3
    v_mov_b64_dpp v[50:51], v[42:43] row_newbcast:3 row_mask:0xf bank_mask:0x3
    v_mfma_f32_16x16x32_bf16 v[52:55], v[16:19], v[44:47], v[52:55]
    ds_read_b64_tr_b16 v[12:13], v6 offset:2816
    ds_read_b64_tr_b16 v[14:15], v6 offset:2944
    v_add_f32_dpp v2, v2, v2 row_ror:8 row_mask:0xf bank_mask:0xf
    v_add_f32_dpp v3, v3, v3 row_ror:8 row_mask:0xf bank_mask:0xf
    v_mov_b64_dpp v[44:45], v[40:41] row_newbcast:4 row_mask:0xf bank_mask:0x3
    v_mov_b64_dpp v[46:47], v[42:43] row_newbcast:4 row_mask:0xf bank_mask:0x3
    v_mfma_f32_16x16x32_bf16 v[52:55], v[20:23], v[48:51], v[52:55]
    ds_read_b64_tr_b16 v[16:17], v6 offset:3072
    ds_read_b64_tr_b16 v[18:19], v6 offset:3200
    v_add_f32_dpp v2, v2, v2 row_ror:4 row_mask:0xf bank_mask:0xf
    v_add_f32_dpp v3, v3, v3 row_ror:4 row_mask:0xf bank_mask:0xf
    v_mov_b64_dpp v[48:49], v[40:41] row_newbcast:5 row_mask:0xf bank_mask:0x3
    v_mov_b64_dpp v[50:51], v[42:43] row_newbcast:5 row_mask:0xf bank_mask:0x3
    v_mfma_f32_16x16x32_bf16 v[52:55], v[24:27], v[44:47], v[52:55]
    ds_read_b64_tr_b16 v[20:21], v6 offset:3328
    ds_read_b64_tr_b16 v[22:23], v6 offset:3456
    v_add_f32_dpp v2, v2, v2 row_ror:2 row_mask:0xf bank_mask:0xf
    v_add_f32_dpp v3, v3, v3 row_ror:2 row_mask:0xf bank_mask:0xf
    v_mov_b64_dpp v[44:45], v[40:41] row_newbcast:6 row_mask:0xf bank_mask:0x3
    v_mov_b64_dpp v[46:47], v[42:43] row_newbcast:6 row_mask:0xf bank_mask:0x3
    v_mfma_f32_16x16x32_bf16 v[52:55], v[28:31], v[48:51], v[52:55]
    v_add_f32_dpp v2, v2, v2 row_ror:1 row_mask:0xf bank_mask:0xf
    v_add_f32_dpp v3, v3, v3 row_ror:1 row_mask:0xf bank_mask:0xf
    v_mov_b32 v4, v2
    v_mov_b32 v5, v3
    v_mov_b64_dpp v[48:49], v[40:41] row_newbcast:7 row_mask:0xf bank_mask:0x3
    v_mov_b64_dpp v[50:51], v[42:43] row_newbcast:7 row_mask:0xf bank_mask:0x3
    v_mfma_f32_16x16x32_bf16 v[52:55], v[32:35], v[44:47], v[52:55]
    v_permlane16_swap_b32 v2, v4
    v_permlane16_swap_b32 v3, v5
    v_add_f32 v2, v2, v4
    v_add_f32 v3, v3, v5
    v_mov_b32 v4, v2
    v_mov_b32 v5, v3
    v_mov_b64_dpp v[44:45], v[40:41] row_newbcast:8 row_mask:0xf bank_mask:0x3
    v_mov_b64_dpp v[46:47], v[42:43] row_newbcast:8 row_mask:0xf bank_mask:0x3
    v_mfma_f32_16x16x32_bf16 v[52:55], v[36:39], v[48:51], v[52:55]
    v_permlane32_swap_b32 v2, v4
    v_permlane32_swap_b32 v3, v5
    v_add_f32 v2, v2, v4
    v_add_f32 v3, v3, v5
    v_mov_b64_dpp v[48:49], v[40:41] row_newbcast:9 row_mask:0xf bank_mask:0x3
    v_mov_b64_dpp v[50:51], v[42:43] row_newbcast:9 row_mask:0xf bank_mask:0x3
    v_mfma_f32_16x16x32_bf16 v[52:55], v[56:59], v[44:47], v[52:55]
    v_mul_f32 v2, 0x3b124925, v2
    v_mul_f32 v3, 0x3b124925, v3
    v_fma_f32 v3, -v2, v2, v3
    v_mov_b64_dpp v[44:45], v[40:41] row_newbcast:10 row_mask:0xf bank_mask:0x3
    v_mov_b64_dpp v[46:47], v[42:43] row_newbcast:10 row_mask:0xf bank_mask:0x3
    v_mfma_f32_16x16x32_bf16 v[52:55], v[60:63], v[48:51], v[52:55]
    v_max_f32 v3, 0, v3
    v_add_f32 v3, 0x3727c5ac, v3
    v_rsq_f32 v3, v3
    v_mov_b64_dpp v[48:49], v[40:41] row_newbcast:11 row_mask:0xf bank_mask:0x3
    v_mov_b64_dpp v[50:51], v[42:43] row_newbcast:11 row_mask:0xf bank_mask:0x3
    s_waitcnt lgkmcnt(6)
    v_mfma_f32_16x16x32_bf16 v[52:55], v[8:11], v[44:47], v[52:55]
    v_mul_f32 v2, v2, v3
    v_mov_b64_dpp v[44:45], v[40:41] row_newbcast:12 row_mask:0xf bank_mask:0x3
    v_mov_b64_dpp v[46:47], v[42:43] row_newbcast:12 row_mask:0xf bank_mask:0x3
    s_waitcnt lgkmcnt(4)
    v_mfma_f32_16x16x32_bf16 v[52:55], v[12:15], v[48:51], v[52:55]
    v_mov_b64_dpp v[48:49], v[40:41] row_newbcast:13 row_mask:0xf bank_mask:0x3
    v_mov_b64_dpp v[50:51], v[42:43] row_newbcast:13 row_mask:0xf bank_mask:0x3
    s_waitcnt lgkmcnt(2)
    v_mfma_f32_16x16x32_bf16 v[52:55], v[16:19], v[44:47], v[52:55]
    s_nop 1
    s_waitcnt lgkmcnt(0)
    v_mfma_f32_16x16x32_bf16 v[52:55], v[20:23], v[48:51], v[52:55]
    v_lshrrev_b32 v48, 4, v1
    v_mov_b32 v49, s90
    v_lshlrev_b32 v50, 1, v1
    v_add_u32 v50, 24576, v50
    s_mov_b32 s56, 0x10001
    s_nop 2
    v_mul_f32_dpp v44, v52, v2 row_shl:8 row_mask:0xf bank_mask:0xf
    v_mul_f32_dpp v45, v53, v2 row_shl:8 row_mask:0xf bank_mask:0xf
    v_mul_f32_dpp v46, v54, v2 row_shl:8 row_mask:0xf bank_mask:0xf
    v_mul_f32_dpp v47, v55, v2 row_shl:8 row_mask:0xf bank_mask:0xf
    v_fma_f32 v52, v52, v3, -v44
    v_fma_f32 v53, v53, v3, -v45
    v_fma_f32 v54, v54, v3, -v46
    v_fma_f32 v55, v55, v3, -v47
    v_cvt_pk_bf16_f32 v52, v52, v53
    v_cvt_pk_bf16_f32 v53, v54, v55
    v_perm_b32 v40, v52, v49, s6
    v_perm_b32 v41, v52, v49, s7
    v_perm_b32 v42, v53, v49, s6
    v_perm_b32 v43, v53, v49, s7
    s_cmp_eq_u32 s2, 0
    s_cbranch_scc1 .Lret
    s_cmp_eq_u32 s58, 1
    s_mov_b32 exec_lo, s56
    s_mov_b32 exec_hi, s56
    s_cbranch_scc0 .ss15
    buffer_store_dwordx4 v[40:43], v48, s[24:27], s77 offen
.sb16:
    s_mov_b64 exec, -1
    buffer_load_dwordx4 v[40:43], v50, s[36:39], 0 offen sc1
    buffer_load_dwordx4 v[44:47], v50, s[36:39], 0 offen offset:16 sc1
    v_bfe_u32 v58, v1, 4, 4
    v_bfe_u32 v59, v1, 8, 2
    v_lshlrev_b32 v3, 11, v59
    v_lshl_add_u32 v3, v58, 4, v3
    v_bfe_u32 v63, v1, 5, 1
    v_lshlrev_b32 v63, 9, v63
    v_lshl_add_u32 v63, v59, 4, v63
    v_and_b32 v59, 16, v1
    v_lshl_add_u32 v63, v59, 2, v63
    v_lshrrev_b32 v58, 2, v58
    v_lshl_add_u32 v2, v58, 11, v63
    v_add_u32 v63, 159872, v63
    v_mov_b32 v62, 0xffff
    v_lshlrev_b32 v62, v59, v62
    v_mov_b32 v4, 161664
    v_mov_b32 v5, 161664
    v_mov_b32 v6, 161664
    v_mov_b32 v7, 161664
    s_nop 0
    v_mov_b32_dpp v4, v63 quad_perm:[0,1,2,3] row_mask:0xf bank_mask:0x1
    v_mov_b32_dpp v5, v63 quad_perm:[0,1,2,3] row_mask:0xf bank_mask:0x2
    v_mov_b32_dpp v6, v63 quad_perm:[0,1,2,3] row_mask:0xf bank_mask:0x4
    v_mov_b32_dpp v7, v63 quad_perm:[0,1,2,3] row_mask:0xf bank_mask:0x8
    v_add_u32 v51, 159872, v1
    v_mov_b32 v63, 0xf149f2ca
    v_mov_b32 v16, 0
    v_mov_b32 v24, 0
    v_mov_b32_dpp v16, v63 quad_perm:[0,1,2,3] row_mask:0xf bank_mask:0xc
    v_mov_b32_dpp v24, v63 quad_perm:[0,1,2,3] row_mask:0xf bank_mask:0x3
    v_mov_b32 v17, v16
    v_mov_b32 v25, v24
    v_mov_b32 v18, v16
    v_mov_b32 v26, v24
    v_mov_b32 v19, v16
    v_mov_b32 v27, v24
    v_mov_b32 v20, v16
    v_mov_b32 v28, v24
    v_mov_b32 v21, v16
    v_mov_b32 v29, v24
    v_mov_b32 v22, v16
    v_mov_b32 v30, v24
    v_mov_b32 v23, v16
    v_mov_b32 v31, v24
    s_add_u32 s59, s59, 1
    s_mov_b32 s89, 4
    s_add_u32 s90, s90, 0x1010101
    s_xor_b32 s72, s72, 1048576
    s_xor_b32 s73, s73, 1048576
    s_xor_b32 s74, s74, 1048576
.pw19:
    s_waitcnt vmcnt(0)
    v_xor_b32 v48, s86, v40
    v_bitop3_b32 v48, v48, v41, s87 bitop3:0xf6
    v_bitop3_b32 v48, v48, v44, s86 bitop3:0xf6
    v_bitop3_b32 v48, v48, v45, s87 bitop3:0xf6
    v_and_b32 v48, 0xffff, v48
    v_cmp_ne_u32 vcc, 0, v48
    s_cbranch_vccnz .pr17
.pd18:
    s_mov_b64 exec, -1
    v_perm_b32 v40, v41, v40, s7
    v_perm_b32 v41, v43, v42, s7
    v_perm_b32 v42, v45, v44, s7
    v_perm_b32 v43, v47, v46, s7
    ds_write_b128 v51, v[40:43]
    s_cmp_eq_u32 s59, 2
    s_waitcnt lgkmcnt(0)
.Lqready:
    s_barrier
    s_cbranch_scc1 .LlayerA
    s_cmp_eq_u32 s59, 1
    s_cbranch_scc1 .Llayer1
.Llayer3:
    ds_read_b128 v[24:27], v4 offset:0
    ds_read_b128 v[28:31], v5 offset:0
    ds_read_b128 v[32:35], v4 offset:128
    ds_read_b128 v[36:39], v5 offset:128
    ds_read_b128 v[40:43], v4 offset:256
    ds_read_b128 v[44:47], v5 offset:256
    ds_read_b128 v[48:51], v4 offset:384
    ds_read_b128 v[52:55], v5 offset:384
    s_waitcnt lgkmcnt(7)
    v_mfma_f32_16x16x32_bf16 v[16:19], a[128:131], v[24:27], v[16:19]
    v_mfma_f32_16x16x32_bf16 v[20:23], a[132:135], v[24:27], v[20:23]
    s_waitcnt lgkmcnt(6)
    v_mfma_f32_16x16x32_bf16 v[16:19], a[160:163], v[28:31], v[16:19]
    v_mfma_f32_16x16x32_bf16 v[20:23], a[164:167], v[28:31], v[20:23]
    s_waitcnt lgkmcnt(5)
    v_mfma_f32_16x16x32_bf16 v[16:19], a[136:139], v[32:35], v[16:19]
    v_mfma_f32_16x16x32_bf16 v[20:23], a[140:143], v[32:35], v[20:23]
    s_waitcnt lgkmcnt(4)
    v_mfma_f32_16x16x32_bf16 v[16:19], a[168:171], v[36:39], v[16:19]
    v_mfma_f32_16x16x32_bf16 v[20:23], a[172:175], v[36:39], v[20:23]
    s_waitcnt lgkmcnt(3)
    v_mfma_f32_16x16x32_bf16 v[16:19], a[144:147], v[40:43], v[16:19]
    v_mfma_f32_16x16x32_bf16 v[20:23], a[148:151], v[40:43], v[20:23]
    s_waitcnt lgkmcnt(2)
    v_mfma_f32_16x16x32_bf16 v[16:19], a[176:179], v[44:47], v[16:19]
    v_mfma_f32_16x16x32_bf16 v[20:23], a[180:183], v[44:47], v[20:23]
    s_waitcnt lgkmcnt(1)
    v_mfma_f32_16x16x32_bf16 v[16:19], a[152:155], v[48:51], v[16:19]
    v_mfma_f32_16x16x32_bf16 v[20:23], a[156:159], v[48:51], v[20:23]
    s_waitcnt lgkmcnt(0)
    v_mfma_f32_16x16x32_bf16 v[16:19], a[184:187], v[52:55], v[16:19]
    v_mfma_f32_16x16x32_bf16 v[20:23], a[188:191], v[52:55], v[20:23]
    v_mov_b32 v40, 0
    v_mov_b32 v41, 0
    v_mov_b32 v42, 0
    v_mov_b32 v43, 0
    v_mov_b32 v44, 0
    v_mov_b32 v45, 0
    v_mov_b32 v46, 0
    v_mov_b32 v47, 0
    v_add_f32_dpp v8, v17, v16 quad_perm:[1,1,3,3] row_mask:0xf bank_mask:0xf
    v_add_f32_dpp v9, v19, v18 quad_perm:[1,1,3,3] row_mask:0xf bank_mask:0xf
    v_add_f32_dpp v10, v21, v20 quad_perm:[1,1,3,3] row_mask:0xf bank_mask:0xf
    v_add_f32_dpp v11, v23, v22 quad_perm:[1,1,3,3] row_mask:0xf bank_mask:0xf
    v_max3_f32 v60, v8, v9, v10
    v_max_f32 v60, v60, v11
    v_mov_b32 v48, 0
    v_mov_b32 v49, 0
    v_max_f32_dpp v60, v60, v60 row_ror:4 row_mask:0xf bank_mask:0xf
    v_mov_b32 v50, 0
    v_mov_b32 v51, 0
    v_max_f32_dpp v60, v60, v60 row_ror:8 row_mask:0xf bank_mask:0xf
    v_mov_b32 v63, v60
    v_mov_b32 v52, 0
    v_mov_b32 v53, 0
    v_permlane16_swap_b32 v60, v63
    v_max_f32 v60, v60, v63
    v_mov_b32 v63, v60
    v_mov_b32 v54, 0
    v_mov_b32 v55, 0
    v_permlane32_swap_b32 v60, v63
    v_max_f32 v60, v60, v63
    v_mul_f32 v60, s57, v60
    v_sub_f32 v60, 0, v60
    v_fma_f32 v8, v8, s57, v60
    v_fma_f32 v9, v9, s57, v60
    v_fma_f32 v10, v10, s57, v60
    v_fma_f32 v11, v11, s57, v60
    v_exp_f32 v8, v8
    v_exp_f32 v9, v9
    v_exp_f32 v10, v10
    v_exp_f32 v11, v11
    v_mov_b32 v56, 0
    v_mov_b32 v57, 0
    v_mov_b32 v58, 0
    v_mov_b32 v59, 0
    v_add_f32 v61, v8, v9
    v_add_f32 v63, v10, v11
    v_cvt_pk_bf16_f32 v8, v8, v8
    v_cvt_pk_bf16_f32 v9, v9, v9
    v_cvt_pk_bf16_f32 v10, v10, v10
    v_cvt_pk_bf16_f32 v11, v11, v11
    v_add_f32 v61, v61, v63
    v_and_b32_dpp v8, v8, v62 quad_perm:[0,0,2,2] row_mask:0xf bank_mask:0xf
    v_and_b32_dpp v9, v9, v62 quad_perm:[0,0,2,2] row_mask:0xf bank_mask:0xf
    v_and_b32_dpp v10, v10, v62 quad_perm:[0,0,2,2] row_mask:0xf bank_mask:0xf
    v_and_b32_dpp v11, v11, v62 quad_perm:[0,0,2,2] row_mask:0xf bank_mask:0xf
    v_bfe_u32 v16, v1, 4, 3
    v_bfe_u32 v17, v1, 7, 1
    v_lshl_add_u32 v16, v17, 5, v16
    v_mul_u32_u24 v16, 896, v16
    v_bfe_u32 v17, v1, 8, 2
    v_lshl_add_u32 v16, v17, 4, v16
    buffer_load_dwordx4 v[24:27], v16, s[32:35], s82 offen
    buffer_load_dwordx4 v[28:31], v16, s[32:35], s83 offen
    buffer_load_dwordx4 v[32:35], v16, s[32:35], s84 offen
    buffer_load_dwordx4 v[36:39], v16, s[32:35], s85 offen
    v_mov_b32_dpp v48, v8 quad_perm:[0,1,2,3] row_mask:0xf bank_mask:0x1
    v_mov_b32_dpp v49, v8 row_shr:4 row_mask:0xf bank_mask:0x2
    v_mov_b32_dpp v50, v8 row_shr:8 row_mask:0xf bank_mask:0x4
    v_mov_b32_dpp v51, v8 row_shr:12 row_mask:0xf bank_mask:0x8
    v_mov_b32_dpp v52, v9 quad_perm:[0,1,2,3] row_mask:0xf bank_mask:0x1
    v_mov_b32_dpp v53, v9 row_shr:4 row_mask:0xf bank_mask:0x2
    v_mov_b32_dpp v54, v9 row_shr:8 row_mask:0xf bank_mask:0x4
    v_mov_b32_dpp v55, v9 row_shr:12 row_mask:0xf bank_mask:0x8
    v_mfma_f32_16x16x32_bf16 v[40:43], v[64:67], v[48:51], v[40:43]
    v_mov_b32_dpp v56, v10 quad_perm:[0,1,2,3] row_mask:0xf bank_mask:0x1
    v_mov_b32_dpp v57, v10 row_shr:4 row_mask:0xf bank_mask:0x2
    v_mfma_f32_16x16x32_bf16 v[44:47], v[68:71], v[48:51], v[44:47]
    v_mov_b32_dpp v58, v10 row_shr:8 row_mask:0xf bank_mask:0x4
    v_mov_b32_dpp v59, v10 row_shr:12 row_mask:0xf bank_mask:0x8
    v_mfma_f32_16x16x32_bf16 v[40:43], v[72:75], v[52:55], v[40:43]
    v_mov_b32_dpp v48, v11 quad_perm:[0,1,2,3] row_mask:0xf bank_mask:0x1
    v_mov_b32_dpp v49, v11 row_shr:4 row_mask:0xf bank_mask:0x2
    v_mfma_f32_16x16x32_bf16 v[44:47], v[76:79], v[52:55], v[44:47]
    v_mov_b32_dpp v50, v11 row_shr:8 row_mask:0xf bank_mask:0x4
    v_mov_b32_dpp v51, v11 row_shr:12 row_mask:0xf bank_mask:0x8
    v_mfma_f32_16x16x32_bf16 v[40:43], v[80:83], v[56:59], v[40:43]
    v_mov_b32_dpp v52, v8 row_shl:4 row_mask:0xf bank_mask:0x1
    v_mov_b32_dpp v53, v8 quad_perm:[0,1,2,3] row_mask:0xf bank_mask:0x2
    v_mfma_f32_16x16x32_bf16 v[44:47], v[84:87], v[56:59], v[44:47]
    v_mov_b32_dpp v54, v8 row_shr:4 row_mask:0xf bank_mask:0x4
    v_mov_b32_dpp v55, v8 row_shr:8 row_mask:0xf bank_mask:0x8
    v_mfma_f32_16x16x32_bf16 v[40:43], v[88:91], v[48:51], v[40:43]
    v_mov_b32_dpp v56, v9 row_shl:4 row_mask:0xf bank_mask:0x1
    v_mov_b32_dpp v57, v9 quad_perm:[0,1,2,3] row_mask:0xf bank_mask:0x2
    v_mfma_f32_16x16x32_bf16 v[44:47], v[92:95], v[48:51], v[44:47]
    v_mov_b32_dpp v58, v9 row_shr:4 row_mask:0xf bank_mask:0x4
    v_mov_b32_dpp v59, v9 row_shr:8 row_mask:0xf bank_mask:0x8
    v_mfma_f32_16x16x32_bf16 v[40:43], v[96:99], v[52:55], v[40:43]
    v_mov_b32_dpp v48, v10 row_shl:4 row_mask:0xf bank_mask:0x1
    v_mov_b32_dpp v49, v10 quad_perm:[0,1,2,3] row_mask:0xf bank_mask:0x2
    v_mfma_f32_16x16x32_bf16 v[44:47], v[100:103], v[52:55], v[44:47]
    v_mov_b32_dpp v50, v10 row_shr:4 row_mask:0xf bank_mask:0x4
    v_mov_b32_dpp v51, v10 row_shr:8 row_mask:0xf bank_mask:0x8
    v_mfma_f32_16x16x32_bf16 v[40:43], v[104:107], v[56:59], v[40:43]
    v_mov_b32_dpp v52, v11 row_shl:4 row_mask:0xf bank_mask:0x1
    v_mov_b32_dpp v53, v11 quad_perm:[0,1,2,3] row_mask:0xf bank_mask:0x2
    v_mfma_f32_16x16x32_bf16 v[44:47], v[108:111], v[56:59], v[44:47]
    v_mov_b32_dpp v54, v11 row_shr:4 row_mask:0xf bank_mask:0x4
    v_mov_b32_dpp v55, v11 row_shr:8 row_mask:0xf bank_mask:0x8
    v_mfma_f32_16x16x32_bf16 v[40:43], v[112:115], v[48:51], v[40:43]
    v_mfma_f32_16x16x32_bf16 v[44:47], v[116:119], v[48:51], v[44:47]
    v_mfma_f32_16x16x32_bf16 v[40:43], v[120:123], v[52:55], v[40:43]
    v_mfma_f32_16x16x32_bf16 v[44:47], v[124:127], v[52:55], v[44:47]
    s_branch .Lchain
.Lret:
    s_setpc_b64 s[64:65]
.Llayer1:
    v_add_u32 v61, s63, v1
    ds_read_b128 v[40:43], v6 offset:0
    ds_read_b128 v[8:11], v61 offset:0
    ds_read_b128 v[12:15], v61 offset:1024
    ds_read_b128 v[44:47], v7 offset:0
    ds_read_b128 v[16:19], v61 offset:8192
    ds_read_b128 v[20:23], v61 offset:9216
    ds_read_b128 v[48:51], v6 offset:128
    ds_read_b128 v[32:35], v61 offset:2048
    ds_read_b128 v[36:39], v61 offset:3072
    ds_read_b128 v[52:55], v7 offset:128
    ds_read_b128 v[56:59], v6 offset:256
    s_waitcnt lgkmcnt(9)
    v_mfma_f32_16x16x32_bf16 v[24:27], v[8:11], v[40:43], v[24:27]
    s_waitcnt lgkmcnt(8)
    v_mfma_f32_16x16x32_bf16 v[28:31], v[12:15], v[40:43], v[28:31]
    ds_read_b128 v[8:11], v61 offset:10240
    s_waitcnt lgkmcnt(7)
    v_mfma_f32_16x16x32_bf16 v[24:27], v[16:19], v[44:47], v[24:27]
    ds_read_b128 v[12:15], v61 offset:11264
    ds_read_b128 v[40:43], v7 offset:256
    s_waitcnt lgkmcnt(8)
    v_mfma_f32_16x16x32_bf16 v[28:31], v[20:23], v[44:47], v[28:31]
    ds_read_b128 v[16:19], v61 offset:4096
    s_waitcnt lgkmcnt(7)
    v_mfma_f32_16x16x32_bf16 v[24:27], v[32:35], v[48:51], v[24:27]
    ds_read_b128 v[20:23], v61 offset:5120
    ds_read_b128 v[44:47], v6 offset:384
    s_waitcnt lgkmcnt(8)
    v_mfma_f32_16x16x32_bf16 v[28:31], v[36:39], v[48:51], v[28:31]
    ds_read_b128 v[32:35], v61 offset:12288
    s_waitcnt lgkmcnt(6)
    v_mfma_f32_16x16x32_bf16 v[24:27], v[8:11], v[52:55], v[24:27]
    ds_read_b128 v[36:39], v61 offset:13312
    ds_read_b128 v[48:51], v7 offset:384
    s_waitcnt lgkmcnt(7)
    v_mfma_f32_16x16x32_bf16 v[28:31], v[12:15], v[52:55], v[28:31]
    ds_read_b128 v[8:11], v61 offset:6144
    s_waitcnt lgkmcnt(6)
    v_mfma_f32_16x16x32_bf16 v[24:27], v[16:19], v[56:59], v[24:27]
    ds_read_b128 v[12:15], v61 offset:7168
    s_waitcnt lgkmcnt(6)
    v_mfma_f32_16x16x32_bf16 v[28:31], v[20:23], v[56:59], v[28:31]
    ds_read_b128 v[16:19], v61 offset:14336
    s_waitcnt lgkmcnt(5)
    v_mfma_f32_16x16x32_bf16 v[24:27], v[32:35], v[40:43], v[24:27]
    ds_read_b128 v[20:23], v61 offset:15360
    s_waitcnt lgkmcnt(5)
    v_mfma_f32_16x16x32_bf16 v[28:31], v[36:39], v[40:43], v[28:31]
    s_waitcnt lgkmcnt(3)
    v_mfma_f32_16x16x32_bf16 v[24:27], v[8:11], v[44:47], v[24:27]
    s_waitcnt lgkmcnt(2)
    v_mfma_f32_16x16x32_bf16 v[28:31], v[12:15], v[44:47], v[28:31]
    s_waitcnt lgkmcnt(1)
    v_mfma_f32_16x16x32_bf16 v[24:27], v[16:19], v[48:51], v[24:27]
    s_waitcnt lgkmcnt(0)
    v_mfma_f32_16x16x32_bf16 v[28:31], v[20:23], v[48:51], v[28:31]
    v_mov_b32 v40, 0
    v_mov_b32 v41, 0
    v_mov_b32 v42, 0
    v_mov_b32 v43, 0
    v_mov_b32 v44, 0
    v_mov_b32 v45, 0
    v_mov_b32 v46, 0
    v_mov_b32 v47, 0
    v_add_f32_dpp v12, v25, v24 quad_perm:[1,1,3,3] row_mask:0xf bank_mask:0xf
    v_add_f32_dpp v13, v27, v26 quad_perm:[1,1,3,3] row_mask:0xf bank_mask:0xf
    v_add_f32_dpp v14, v29, v28 quad_perm:[1,1,3,3] row_mask:0xf bank_mask:0xf
    v_add_f32_dpp v15, v31, v30 quad_perm:[1,1,3,3] row_mask:0xf bank_mask:0xf
    v_max3_f32 v60, v12, v13, v14
    v_max_f32 v60, v60, v15
    v_mov_b32 v48, 0
    v_mov_b32 v49, 0
    v_max_f32_dpp v60, v60, v60 row_ror:4 row_mask:0xf bank_mask:0xf
    v_mov_b32 v50, 0
    v_mov_b32 v51, 0
    v_max_f32_dpp v60, v60, v60 row_ror:8 row_mask:0xf bank_mask:0xf
    v_mov_b32 v63, v60
    v_mov_b32 v52, 0
    v_mov_b32 v53, 0
    v_permlane16_swap_b32 v60, v63
    v_max_f32 v60, v60, v63
    v_mov_b32 v63, v60
    v_mov_b32 v54, 0
    v_mov_b32 v55, 0
    v_permlane32_swap_b32 v60, v63
    v_max_f32 v60, v60, v63
    v_mul_f32 v60, s57, v60
    v_sub_f32 v60, 0, v60
    v_fma_f32 v12, v12, s57, v60
    v_fma_f32 v13, v13, s57, v60
    v_fma_f32 v14, v14, s57, v60
    v_fma_f32 v15, v15, s57, v60
    v_exp_f32 v12, v12
    v_exp_f32 v13, v13
    v_exp_f32 v14, v14
    v_exp_f32 v15, v15
    v_mov_b32 v56, 0
    v_mov_b32 v57, 0
    v_mov_b32 v58, 0
    v_mov_b32 v59, 0
    v_add_f32 v61, v12, v13
    v_add_f32 v63, v14, v15
    v_cvt_pk_bf16_f32 v12, v12, v12
    v_cvt_pk_bf16_f32 v13, v13, v13
    v_cvt_pk_bf16_f32 v14, v14, v14
    v_cvt_pk_bf16_f32 v15, v15, v15
    v_add_f32 v61, v61, v63
    v_and_b32_dpp v12, v12, v62 quad_perm:[0,0,2,2] row_mask:0xf bank_mask:0xf
    v_and_b32_dpp v13, v13, v62 quad_perm:[0,0,2,2] row_mask:0xf bank_mask:0xf
    v_and_b32_dpp v14, v14, v62 quad_perm:[0,0,2,2] row_mask:0xf bank_mask:0xf
    v_and_b32_dpp v15, v15, v62 quad_perm:[0,0,2,2] row_mask:0xf bank_mask:0xf
    s_waitcnt vmcnt(1)
    s_barrier
sub_pvlds:
    v_add_u32 v63, s66, v1
    ds_read_b128 v[16:19], v63 offset:0
    ds_read_b128 v[20:23], v63 offset:1024
    ds_read_b128 v[24:27], v63 offset:2048
    ds_read_b128 v[28:31], v63 offset:3072
    ds_read_b128 v[32:35], v63 offset:4096
    ds_read_b128 v[36:39], v63 offset:5120
    v_mov_b32_dpp v48, v12 row_shl:8 row_mask:0xf bank_mask:0x1
    v_mov_b32_dpp v49, v12 row_shl:4 row_mask:0xf bank_mask:0x2
    v_mov_b32_dpp v50, v12 quad_perm:[0,1,2,3] row_mask:0xf bank_mask:0x4
    v_mov_b32_dpp v51, v12 row_shr:4 row_mask:0xf bank_mask:0x8
    v_mov_b32_dpp v52, v13 row_shl:8 row_mask:0xf bank_mask:0x1
    v_mov_b32_dpp v53, v13 row_shl:4 row_mask:0xf bank_mask:0x2
    v_mov_b32_dpp v54, v13 quad_perm:[0,1,2,3] row_mask:0xf bank_mask:0x4
    v_mov_b32_dpp v55, v13 row_shr:4 row_mask:0xf bank_mask:0x8
    s_waitcnt lgkmcnt(4)
    v_mfma_f32_16x16x32_bf16 v[40:43], v[16:19], v[48:51], v[40:43]
    v_mov_b32_dpp v56, v14 row_shl:8 row_mask:0xf bank_mask:0x1
    v_mov_b32_dpp v57, v14 row_shl:4 row_mask:0xf bank_mask:0x2
    v_mfma_f32_16x16x32_bf16 v[44:47], v[20:23], v[48:51], v[44:47]
    v_mov_b32_dpp v58, v14 quad_perm:[0,1,2,3] row_mask:0xf bank_mask:0x4
    v_mov_b32_dpp v59, v14 row_shr:4 row_mask:0xf bank_mask:0x8
    s_waitcnt lgkmcnt(2)
    v_mfma_f32_16x16x32_bf16 v[40:43], v[24:27], v[52:55], v[40:43]
    v_mov_b32_dpp v48, v15 row_shl:8 row_mask:0xf bank_mask:0x1
    v_mov_b32_dpp v49, v15 row_shl:4 row_mask:0xf bank_mask:0x2
    v_mfma_f32_16x16x32_bf16 v[44:47], v[28:31], v[52:55], v[44:47]
    v_mov_b32_dpp v50, v15 quad_perm:[0,1,2,3] row_mask:0xf bank_mask:0x4
    v_mov_b32_dpp v51, v15 row_shr:4 row_mask:0xf bank_mask:0x8
    ds_read_b128 v[16:19], v63 offset:6144
    ds_read_b128 v[20:23], v63 offset:7168
    s_waitcnt lgkmcnt(2)
    v_mfma_f32_16x16x32_bf16 v[40:43], v[32:35], v[56:59], v[40:43]
    v_mov_b32_dpp v52, v12 row_shl:12 row_mask:0xf bank_mask:0x1
    v_mov_b32_dpp v53, v12 row_shl:8 row_mask:0xf bank_mask:0x2
    v_mfma_f32_16x16x32_bf16 v[44:47], v[36:39], v[56:59], v[44:47]
    v_mov_b32_dpp v54, v12 row_shl:4 row_mask:0xf bank_mask:0x4
    v_mov_b32_dpp v55, v12 quad_perm:[0,1,2,3] row_mask:0xf bank_mask:0x8
    ds_read_b128 v[24:27], v63 offset:8192
    ds_read_b128 v[28:31], v63 offset:9216
    s_waitcnt lgkmcnt(2)
    v_mfma_f32_16x16x32_bf16 v[40:43], v[16:19], v[48:51], v[40:43]
    v_mov_b32_dpp v56, v13 row_shl:12 row_mask:0xf bank_mask:0x1
    v_mov_b32_dpp v57, v13 row_shl:8 row_mask:0xf bank_mask:0x2
    v_mfma_f32_16x16x32_bf16 v[44:47], v[20:23], v[48:51], v[44:47]
    v_mov_b32_dpp v58, v13 row_shl:4 row_mask:0xf bank_mask:0x4
    v_mov_b32_dpp v59, v13 quad_perm:[0,1,2,3] row_mask:0xf bank_mask:0x8
    ds_read_b128 v[32:35], v63 offset:10240
    ds_read_b128 v[36:39], v63 offset:11264
    s_waitcnt lgkmcnt(2)
    v_mfma_f32_16x16x32_bf16 v[40:43], v[24:27], v[52:55], v[40:43]
    v_mov_b32_dpp v48, v14 row_shl:12 row_mask:0xf bank_mask:0x1
    v_mov_b32_dpp v49, v14 row_shl:8 row_mask:0xf bank_mask:0x2
    v_mfma_f32_16x16x32_bf16 v[44:47], v[28:31], v[52:55], v[44:47]
    v_mov_b32_dpp v50, v14 row_shl:4 row_mask:0xf bank_mask:0x4
    v_mov_b32_dpp v51, v14 quad_perm:[0,1,2,3] row_mask:0xf bank_mask:0x8
    ds_read_b128 v[16:19], v63 offset:12288
    ds_read_b128 v[20:23], v63 offset:13312
    s_waitcnt lgkmcnt(2)
    v_mfma_f32_16x16x32_bf16 v[40:43], v[32:35], v[56:59], v[40:43]
    v_mov_b32_dpp v52, v15 row_shl:12 row_mask:0xf bank_mask:0x1
    v_mov_b32_dpp v53, v15 row_shl:8 row_mask:0xf bank_mask:0x2
    v_mfma_f32_16x16x32_bf16 v[44:47], v[36:39], v[56:59], v[44:47]
    v_mov_b32_dpp v54, v15 row_shl:4 row_mask:0xf bank_mask:0x4
    v_mov_b32_dpp v55, v15 quad_perm:[0,1,2,3] row_mask:0xf bank_mask:0x8
    ds_read_b128 v[24:27], v63 offset:14336
    ds_read_b128 v[28:31], v63 offset:15360
    s_waitcnt lgkmcnt(2)
    v_mfma_f32_16x16x32_bf16 v[40:43], v[16:19], v[48:51], v[40:43]
    v_mfma_f32_16x16x32_bf16 v[44:47], v[20:23], v[48:51], v[44:47]
    s_waitcnt lgkmcnt(0)
    v_mfma_f32_16x16x32_bf16 v[40:43], v[24:27], v[52:55], v[40:43]
    v_mfma_f32_16x16x32_bf16 v[44:47], v[28:31], v[52:55], v[44:47]
    s_cmp_eq_u32 s59, 0
    s_cbranch_scc1 .Lret
    v_bfe_u32 v16, v1, 4, 3
    v_bfe_u32 v17, v1, 7, 1
    v_lshl_add_u32 v16, v17, 5, v16
    v_mul_u32_u24 v16, 896, v16
    v_bfe_u32 v17, v1, 8, 2
    v_lshl_add_u32 v16, v17, 4, v16
    buffer_load_dwordx4 v[24:27], v16, s[32:35], s82 offen
    buffer_load_dwordx4 v[28:31], v16, s[32:35], s83 offen
    buffer_load_dwordx4 v[32:35], v16, s[32:35], s84 offen
    buffer_load_dwordx4 v[36:39], v16, s[32:35], s85 offen
    s_branch .Lchain
.Lloader:
    s_cmp_eq_u32 s59, 3
    s_cbranch_scc1 .Lfin
    s_bitcmp1_b32 s59, 0
    s_cselect_b32 s32, s44, s46
    s_cselect_b32 s33, s45, s47
    s_cselect_b32 s52, 0, 14336
    s_add_u32 s52, s52, 131072
    v_bfe_u32 v58, v1, 4, 4
    v_bfe_u32 v59, v1, 8, 2
    v_lshlrev_b32 v3, 11, v59
    v_lshl_add_u32 v3, v58, 4, v3
    v_bfe_u32 v63, v1, 5, 1
    v_lshlrev_b32 v63, 9, v63
    v_lshl_add_u32 v63, v59, 4, v63
    v_and_b32 v59, 16, v1
    v_lshl_add_u32 v63, v59, 2, v63
    v_lshrrev_b32 v58, 2, v58
    v_lshl_add_u32 v2, v58, 11, v63
    v_add_u32 v63, 159872, v63
    v_mov_b32 v62, 0xffff
    v_lshlrev_b32 v62, v59, v62
    v_mov_b32 v4, 161664
    v_mov_b32 v5, 161664
    v_mov_b32 v6, 161664
    v_mov_b32 v7, 161664
    s_nop 0
    v_mov_b32_dpp v4, v63 quad_perm:[0,1,2,3] row_mask:0xf bank_mask:0x1
    v_mov_b32_dpp v5, v63 quad_perm:[0,1,2,3] row_mask:0xf bank_mask:0x2
    v_mov_b32_dpp v6, v63 quad_perm:[0,1,2,3] row_mask:0xf bank_mask:0x4
    v_mov_b32_dpp v7, v63 quad_perm:[0,1,2,3] row_mask:0xf bank_mask:0x8
    s_cmp_lg_u32 s59, 0
    s_cbranch_scc1 .Lld_n0
    v_mov_b32 v44, 159824
    ds_read_b32 v45, v44
    s_waitcnt lgkmcnt(0)
    v_readfirstlane_b32 s0, v45
    s_lshl_b32 s1, s3, 18
    s_sub_u32 s1, s55, s1
    s_cmp_gt_u32 s89, 0
    s_cbranch_scc1 .jo20
    s_mov_b32 s50, s55
    s_mov_b32 s51, s63
    s_mov_b32 s67, 0
    s_call_b64 s[64:65], sub_job
.jo20:
    s_cmp_lg_u32 s3, 1
    s_cbranch_scc1 .ow21
    s_cmp_gt_u32 s0, 0
    s_cbranch_scc1 .ow21
    s_mov_b32 s50, s1
    s_mov_b32 s51, 0
    s_mov_b32 s67, 0
    s_call_b64 s[64:65], sub_job
.ow21:
    s_cmp_gt_u32 s89, 1
    s_cbranch_scc1 .jo22
    s_mov_b32 s50, s55
    s_mov_b32 s51, s63
    s_mov_b32 s67, 1
    s_call_b64 s[64:65], sub_job
.jo22:
    s_cmp_lg_u32 s3, 2
    s_cbranch_scc1 .ow23
    s_cmp_gt_u32 s0, 1
    s_cbranch_scc1 .ow23
    s_mov_b32 s50, s1
    s_mov_b32 s51, 0
    s_mov_b32 s67, 1
    s_call_b64 s[64:65], sub_job
.ow23:
    s_cmp_gt_u32 s89, 2
    s_cbranch_scc1 .jo24
    s_mov_b32 s50, s55
    s_mov_b32 s51, s63
    s_mov_b32 s67, 2
    s_call_b64 s[64:65], sub_job
.jo24:
    s_cmp_lg_u32 s3, 3
    s_cbranch_scc1 .ow25
    s_cmp_gt_u32 s0, 2
    s_cbranch_scc1 .ow25
    s_mov_b32 s50, s1
    s_mov_b32 s51, 0
    s_mov_b32 s67, 2
    s_call_b64 s[64:65], sub_job
.ow25:
    s_cmp_lg_u32 s3, 2
    s_cbranch_scc1 .ow26
    s_cmp_gt_u32 s0, 3
    s_cbranch_scc1 .ow26
    s_mov_b32 s50, s1
    s_mov_b32 s51, 0
    s_mov_b32 s67, 3
    s_call_b64 s[64:65], sub_job
.ow26:
    s_cmp_lg_u32 s3, 1
    s_cbranch_scc1 .ow27
    s_call_b64 s[64:65], sub_repair
.ow27:
    s_cmp_gt_u32 s89, 3
    s_cbranch_scc1 .Lld_pre
    s_cmp_gt_u32 s89, 3
    s_cbranch_scc1 .jo28
    s_mov_b32 s50, s55
    s_mov_b32 s51, s63
    s_mov_b32 s67, 3
    s_call_b64 s[64:65], sub_job
.jo28:
    s_waitcnt vmcnt(6)
    s_branch .Lhelp
.Lld_pre:
    s_waitcnt vmcnt(0)
.Lhelp:
    s_cmp_lg_u32 s59, 0
    s_cbranch_scc1 .Lld_done
    v_lshlrev_b32 v58, 3, v1
    s_lshl_b32 s60, s4, 5
    s_add_u32 s60, s60, s5
    s_mul_i32 s60, s60, 14336
    s_mul_i32 s61, s3, 4864
    s_add_u32 s60, s60, s61
    s_sub_u32 s60, s60, 4864
    s_mov_b32 m0, 161408
    s_mov_b32 exec_hi, 0x3f
    buffer_load_dword v58, s[32:35], s60 offen lds
    s_mov_b64 exec, -1
    s_branch .Lld_done
.Lld_n0:
    s_cmp_ge_u32 s5, 28
    s_cbranch_scc1 .Lld_done
    s_call_b64 s[0:1], .Ljobs
.Lld_done:
    v_mov_b32 v63, 0xf149f2ca
    v_mov_b32 v16, 0
    v_mov_b32 v24, 0
    v_mov_b32_dpp v16, v63 quad_perm:[0,1,2,3] row_mask:0xf bank_mask:0xc
    v_mov_b32_dpp v24, v63 quad_perm:[0,1,2,3] row_mask:0xf bank_mask:0x3
    v_mov_b32 v17, v16
    v_mov_b32 v25, v24
    v_mov_b32 v18, v16
    v_mov_b32 v26, v24
    v_mov_b32 v19, v16
    v_mov_b32 v27, v24
    v_mov_b32 v20, v16
    v_mov_b32 v28, v24
    v_mov_b32 v21, v16
    v_mov_b32 v29, v24
    v_mov_b32 v22, v16
    v_mov_b32 v30, v24
    v_mov_b32 v23, v16
    v_mov_b32 v31, v24
    s_add_u32 s59, s59, 1
    s_mov_b32 s89, 4
    s_add_u32 s90, s90, 0x1010101
    s_xor_b32 s72, s72, 1048576
    s_xor_b32 s73, s73, 1048576
    s_xor_b32 s74, s74, 1048576
    s_cmp_eq_u32 s59, 2
    s_branch .Lqready
.Ljobs:
    s_cmp_eq_u32 s59, 1
    s_cbranch_scc1 .Lld_1
    s_call_b64 s[64:65], sub_breg
    s_waitcnt lgkmcnt(0)
    s_setpc_b64 s[0:1]
.Lld_1:
    s_cmp_lg_u32 s3, 1
    s_cbranch_scc1 .ow29
    s_call_b64 s[64:65], sub_repair
    s_waitcnt vmcnt(0)
.ow29:
    s_setpc_b64 s[0:1]
.Lout:
    s_mov_b32 s36, s48
    s_mov_b32 s37, s49
    s_mov_b32 s38, 896
    s_mov_b32 exec_lo, 0xff
    s_mov_b32 exec_hi, 0xff
    buffer_store_dword v40, v42, s[36:39], 0 offen
    s_mov_b64 exec, 1
    s_cmp_lg_u32 s88, 0
    s_cbranch_scc1 .Lnoep
    v_mov_b32 v43, 851968
    buffer_store_dword v41, v43, s[24:27], 0 offen
.Lnoep:
    s_mov_b64 exec, -1
.Lfin:
.Lend:
    s_endpgm
.Lno_s1:
    v_mov_b32 v16, 159824
    v_mov_b32 v17, 3
    ds_write_b32 v16, v17
    s_waitcnt vmcnt(0) lgkmcnt(0)
    s_barrier
    s_cmp_lg_u32 s59, 0
    s_cbranch_scc1 .Ls2a
    s_mov_b32 s50, s55
    s_mov_b32 s51, s63
    s_mov_b32 s67, 0
    s_call_b64 s[64:65], sub_job
    s_mov_b32 s50, s55
    s_mov_b32 s51, s63
    s_mov_b32 s67, 1
    s_call_b64 s[64:65], sub_job
    s_mov_b32 s50, s55
    s_mov_b32 s51, s63
    s_mov_b32 s67, 2
    s_call_b64 s[64:65], sub_job
    s_mov_b32 s89, 3
    s_branch .Ls2b
.Ls2a:
    s_cmp_eq_u32 s59, 3
    s_cbranch_scc1 .Ls2b
    s_call_b64 s[0:1], .Ljobs
.Ls2b:
    s_cmp_lt_u32 s88, 14
    s_cbranch_scc0 .Lloader
    s_cmp_lg_u32 s59, 3
    s_cbranch_scc1 .Ls2
    s_cmp_lg_u32 s4, 0
    s_cbranch_scc1 .Lfin
.Ls2:
    v_lshrrev_b32 v2, 7, v1
    v_mul_u32_u24 v2, 1792, v2
    v_and_b32 v3, 0x70, v1
    v_add_u32 v2, v2, v3
    buffer_load_dwordx4 v[44:47], v2, s[24:27], s73 offen sc1
    buffer_load_dwordx4 v[48:51], v2, s[24:27], s74 offen sc1
    v_lshrrev_b32 v42, 1, v3
    v_lshrrev_b32 v3, 9, v1
    v_lshl_add_u32 v42, v3, 2, v42
    s_lshl_b32 s60, s88, 6
    v_add_u32 v42, s60, v42
    v_lshlrev_b32 v43, 1, v42
    v_lshrrev_b32 v3, 2, v1
    s_lshl_b32 s60, s3, 8
    s_add_u32 s60, s60, 162176
    v_add_u32 v3, s60, v3
    ds_read_b32 v52, v3
    v_bfe_u32 v5, v1, 4, 2
    v_lshlrev_b32 v5, 3, v5
    v_bfe_u32 v5, s90, v5, 8
    v_mov_b32 v41, s90
    s_waitcnt lgkmcnt(0)
    v_lshlrev_b32 v53, 16, v52
    v_and_b32 v52, 0xffff0000, v52
    s_bitcmp1_b32 s59, 0
    s_cselect_b32 s32, s44, s46
    s_cselect_b32 s33, s45, s47
    s_cselect_b32 s52, 0, 14336
    s_add_u32 s52, s52, 131072
    s_and_b32 s86, s90, 0xffff
    s_lshr_b32 s87, s90, 16
    s_add_u32 s36, s24, s75
    s_addc_u32 s37, s25, 0
    s_mov_b32 s38, 26624
    v_bfe_u32 v6, v1, 8, 2
    v_mul_u32_u24 v7, 448, v6
    v_mul_u32_u24 v6, 3584, v6
    v_bfe_u32 v4, v1, 4, 4
    v_lshl_add_u32 v6, v4, 3, v6
    v_add_u32 v6, s52, v6
    v_lshl_add_u32 v7, v4, 5, v7
    v_cmp_gt_u32 vcc, 14, v4
    v_mov_b32 v4, 65536
    s_nop 0
    v_cndmask_b32 v7, v4, v7, vcc
    ds_read_b64_tr_b16 v[8:9], v6 offset:0
    ds_read_b64_tr_b16 v[10:11], v6 offset:128
    ds_read_b64_tr_b16 v[12:13], v6 offset:256
    ds_read_b64_tr_b16 v[14:15], v6 offset:384
    ds_read_b64_tr_b16 v[16:17], v6 offset:512
    ds_read_b64_tr_b16 v[18:19], v6 offset:640
    ds_read_b64_tr_b16 v[20:21], v6 offset:768
    ds_read_b64_tr_b16 v[22:23], v6 offset:896
    ds_read_b64_tr_b16 v[24:25], v6 offset:1024
    ds_read_b64_tr_b16 v[26:27], v6 offset:1152
    ds_read_b64_tr_b16 v[28:29], v6 offset:1280
    ds_read_b64_tr_b16 v[30:31], v6 offset:1408
    ds_read_b64_tr_b16 v[32:33], v6 offset:1536
    ds_read_b64_tr_b16 v[34:35], v6 offset:1664
    ds_read_b64_tr_b16 v[36:37], v6 offset:1792
    ds_read_b64_tr_b16 v[38:39], v6 offset:1920
    ds_read_b64_tr_b16 v[56:57], v6 offset:2048
    ds_read_b64_tr_b16 v[58:59], v6 offset:2176
    ds_read_b64_tr_b16 v[60:61], v6 offset:2304
    ds_read_b64_tr_b16 v[62:63], v6 offset:2432
.pw32:
    s_waitcnt vmcnt(0)
    v_xor_b32 v44, v5, v44
    v_xor_b32 v48, v5, v48
    v_or_b32 v4, v44, v48
    v_and_b32 v4, 0xff, v4
    v_cmp_ne_u32 vcc, 0, v4
    s_cbranch_vccnz .pr30
.pd31:
    s_mov_b64 exec, -1
    v_add_f32 v44, v44, v48
    v_add_f32 v46, v46, v50
    v_add_f32 v45, v45, v49
    v_add_f32 v47, v47, v51
    v_permlane32_swap_b32 v44, v46
    s_cmp_eq_u32 s59, 3
    v_permlane32_swap_b32 v45, v47
    v_add_f32 v44, v44, v46
    v_add_f32 v45, v45, v47
    s_nop 0
    v_add_f32_dpp v44, v44, v44 row_ror:8 row_mask:0xf bank_mask:0xf
    v_add_f32_dpp v45, v45, v45 row_ror:8 row_mask:0xf bank_mask:0xf
    v_mov_b32 v46, v44
    v_mov_b32 v47, v45
    s_nop 0
    v_permlane16_swap_b32 v44, v46
    v_permlane16_swap_b32 v45, v47
    v_add_f32 v44, v44, v46
    v_add_f32 v45, v45, v47
    v_cvt_pk_bf16_f32 v44, v44, v45
    v_and_b32 v45, 0xffff0000, v44
    v_lshlrev_b32 v44, 16, v44
    v_add_f32 v44, v44, v53
    v_add_f32 v45, v45, v52
    v_cvt_pk_bf16_f32 v40, v44, v45
    s_cbranch_scc1 .Lout
    v_perm_b32 v44, v40, v41, s6
    v_perm_b32 v45, v40, v41, s7
    s_cmp_eq_u32 s58, 1
    s_mov_b32 exec_lo, 0xff
    s_mov_b32 exec_hi, 0xff
    s_cbranch_scc0 .ss33
    buffer_store_dwordx2 v[44:45], v43, s[24:27], s75 offen
.sb34:
    s_mov_b64 exec, -1
    ds_write_b32 v3, v40
    s_cmp_eq_u32 s3, 0
    s_cbranch_scc1 .Ls3
    s_waitcnt lgkmcnt(0)
    s_branch .Lloader
sub_qka0:
    ds_read_b128 v[32:35], v4 offset:0
    ds_read_b128 v[36:39], v5 offset:0
    ds_read_b128 v[40:43], v4 offset:128
    ds_read_b128 v[44:47], v5 offset:128
    ds_read_b128 v[48:51], v4 offset:256
    ds_read_b128 v[52:55], v5 offset:256
    s_waitcnt lgkmcnt(5)
    v_mfma_f32_16x16x32_bf16 v[16:19], a[0:3], v[32:35], 0
    v_mfma_f32_16x16x32_bf16 v[20:23], a[4:7], v[32:35], 0
    v_mfma_f32_16x16x32_bf16 v[24:27], a[128:131], v[32:35], 0
    v_mfma_f32_16x16x32_bf16 v[28:31], a[132:135], v[32:35], 0
    s_waitcnt lgkmcnt(4)
    v_mfma_f32_16x16x32_bf16 v[16:19], a[32:35], v[36:39], v[16:19]
    v_mfma_f32_16x16x32_bf16 v[20:23], a[36:39], v[36:39], v[20:23]
    v_mfma_f32_16x16x32_bf16 v[24:27], a[160:163], v[36:39], v[24:27]
    v_mfma_f32_16x16x32_bf16 v[28:31], a[164:167], v[36:39], v[28:31]
    ds_read_b128 v[32:35], v4 offset:384
    s_waitcnt lgkmcnt(4)
    v_mfma_f32_16x16x32_bf16 v[16:19], a[8:11], v[40:43], v[16:19]
    v_mfma_f32_16x16x32_bf16 v[20:23], a[12:15], v[40:43], v[20:23]
    v_mfma_f32_16x16x32_bf16 v[24:27], a[136:139], v[40:43], v[24:27]
    v_mfma_f32_16x16x32_bf16 v[28:31], a[140:143], v[40:43], v[28:31]
    ds_read_b128 v[36:39], v5 offset:384
    s_waitcnt lgkmcnt(4)
    v_mfma_f32_16x16x32_bf16 v[16:19], a[40:43], v[44:47], v[16:19]
    v_mfma_f32_16x16x32_bf16 v[20:23], a[44:47], v[44:47], v[20:23]
    v_mfma_f32_16x16x32_bf16 v[24:27], a[168:171], v[44:47], v[24:27]
    v_mfma_f32_16x16x32_bf16 v[28:31], a[172:175], v[44:47], v[28:31]
    ds_read_b128 v[40:43], v6 offset:0
    s_waitcnt lgkmcnt(4)
    v_mfma_f32_16x16x32_bf16 v[16:19], a[16:19], v[48:51], v[16:19]
    v_mfma_f32_16x16x32_bf16 v[20:23], a[20:23], v[48:51], v[20:23]
    v_mfma_f32_16x16x32_bf16 v[24:27], a[144:147], v[48:51], v[24:27]
    v_mfma_f32_16x16x32_bf16 v[28:31], a[148:151], v[48:51], v[28:31]
    ds_read_b128 v[44:47], v7 offset:0
    s_waitcnt lgkmcnt(4)
    v_mfma_f32_16x16x32_bf16 v[16:19], a[48:51], v[52:55], v[16:19]
    v_mfma_f32_16x16x32_bf16 v[20:23], a[52:55], v[52:55], v[20:23]
    v_mfma_f32_16x16x32_bf16 v[24:27], a[176:179], v[52:55], v[24:27]
    v_mfma_f32_16x16x32_bf16 v[28:31], a[180:183], v[52:55], v[28:31]
    ds_read_b128 v[48:51], v6 offset:128
    s_waitcnt lgkmcnt(4)
    v_mfma_f32_16x16x32_bf16 v[16:19], a[24:27], v[32:35], v[16:19]
    v_mfma_f32_16x16x32_bf16 v[20:23], a[28:31], v[32:35], v[20:23]
    v_mfma_f32_16x16x32_bf16 v[24:27], a[152:155], v[32:35], v[24:27]
    v_mfma_f32_16x16x32_bf16 v[28:31], a[156:159], v[32:35], v[28:31]
    ds_read_b128 v[52:55], v7 offset:128
    s_waitcnt lgkmcnt(4)
    v_mfma_f32_16x16x32_bf16 v[16:19], a[56:59], v[36:39], v[16:19]
    v_mfma_f32_16x16x32_bf16 v[20:23], a[60:63], v[36:39], v[20:23]
    v_mfma_f32_16x16x32_bf16 v[24:27], a[184:187], v[36:39], v[24:27]
    v_mfma_f32_16x16x32_bf16 v[28:31], a[188:191], v[36:39], v[28:31]
    ds_read_b128 v[32:35], v6 offset:256
    s_setpc_b64 s[64:65]
sub_qka1:
    s_waitcnt lgkmcnt(4)
    v_mfma_f32_16x16x32_bf16 v[16:19], a[64:67], v[40:43], v[16:19]
    v_mfma_f32_16x16x32_bf16 v[20:23], a[68:71], v[40:43], v[20:23]
    v_mfma_f32_16x16x32_bf16 v[24:27], a[192:195], v[40:43], v[24:27]
    v_mfma_f32_16x16x32_bf16 v[28:31], a[196:199], v[40:43], v[28:31]
    ds_read_b128 v[36:39], v7 offset:256
    s_waitcnt lgkmcnt(4)
    v_mfma_f32_16x16x32_bf16 v[16:19], a[96:99], v[44:47], v[16:19]
    v_mfma_f32_16x16x32_bf16 v[20:23], a[100:103], v[44:47], v[20:23]
    v_mfma_f32_16x16x32_bf16 v[24:27], a[224:227], v[44:47], v[24:27]
    v_mfma_f32_16x16x32_bf16 v[28:31], a[228:231], v[44:47], v[28:31]
    ds_read_b128 v[40:43], v6 offset:384
    s_waitcnt lgkmcnt(4)
    v_mfma_f32_16x16x32_bf16 v[16:19], a[72:75], v[48:51], v[16:19]
    v_mfma_f32_16x16x32_bf16 v[20:23], a[76:79], v[48:51], v[20:23]
    v_mfma_f32_16x16x32_bf16 v[24:27], a[200:203], v[48:51], v[24:27]
    v_mfma_f32_16x16x32_bf16 v[28:31], a[204:207], v[48:51], v[28:31]
    ds_read_b128 v[44:47], v7 offset:384
    s_waitcnt lgkmcnt(4)
    v_mfma_f32_16x16x32_bf16 v[16:19], a[104:107], v[52:55], v[16:19]
    v_mfma_f32_16x16x32_bf16 v[20:23], a[108:111], v[52:55], v[20:23]
    v_mfma_f32_16x16x32_bf16 v[24:27], a[232:235], v[52:55], v[24:27]
    v_mfma_f32_16x16x32_bf16 v[28:31], a[236:239], v[52:55], v[28:31]
    s_waitcnt lgkmcnt(3)
    v_mfma_f32_16x16x32_bf16 v[16:19], a[80:83], v[32:35], v[16:19]
    v_mfma_f32_16x16x32_bf16 v[20:23], a[84:87], v[32:35], v[20:23]
    v_mfma_f32_16x16x32_bf16 v[24:27], a[208:211], v[32:35], v[24:27]
    v_mfma_f32_16x16x32_bf16 v[28:31], a[212:215], v[32:35], v[28:31]
    s_waitcnt lgkmcnt(2)
    v_mfma_f32_16x16x32_bf16 v[16:19], a[112:115], v[36:39], v[16:19]
    v_mfma_f32_16x16x32_bf16 v[20:23], a[116:119], v[36:39], v[20:23]
    v_mfma_f32_16x16x32_bf16 v[24:27], a[240:243], v[36:39], v[24:27]
    v_mfma_f32_16x16x32_bf16 v[28:31], a[244:247], v[36:39], v[28:31]
    s_waitcnt lgkmcnt(1)
    v_mfma_f32_16x16x32_bf16 v[16:19], a[88:91], v[40:43], v[16:19]
    v_mfma_f32_16x16x32_bf16 v[20:23], a[92:95], v[40:43], v[20:23]
    v_mfma_f32_16x16x32_bf16 v[24:27], a[216:219], v[40:43], v[24:27]
    v_mfma_f32_16x16x32_bf16 v[28:31], a[220:223], v[40:43], v[28:31]
    s_waitcnt lgkmcnt(0)
    v_mfma_f32_16x16x32_bf16 v[16:19], a[120:123], v[44:47], v[16:19]
    v_mfma_f32_16x16x32_bf16 v[20:23], a[124:127], v[44:47], v[20:23]
    v_mfma_f32_16x16x32_bf16 v[24:27], a[248:251], v[44:47], v[24:27]
    v_mfma_f32_16x16x32_bf16 v[28:31], a[252:255], v[44:47], v[28:31]
    v_mov_b32 v40, 0
    v_mov_b32 v41, 0
    v_mov_b32 v42, 0
    v_mov_b32 v43, 0
    v_mov_b32 v44, 0
    v_mov_b32 v45, 0
    v_mov_b32 v46, 0
    v_mov_b32 v47, 0
    v_add_f32_dpp v8, v17, v16 quad_perm:[1,1,3,3] row_mask:0xf bank_mask:0xf
    v_add_f32_dpp v9, v19, v18 quad_perm:[1,1,3,3] row_mask:0xf bank_mask:0xf
    v_add_f32_dpp v10, v21, v20 quad_perm:[1,1,3,3] row_mask:0xf bank_mask:0xf
    v_add_f32_dpp v11, v23, v22 quad_perm:[1,1,3,3] row_mask:0xf bank_mask:0xf
    v_add_f32_dpp v12, v25, v24 quad_perm:[1,1,3,3] row_mask:0xf bank_mask:0xf
    v_add_f32_dpp v13, v27, v26 quad_perm:[1,1,3,3] row_mask:0xf bank_mask:0xf
    v_add_f32_dpp v14, v29, v28 quad_perm:[1,1,3,3] row_mask:0xf bank_mask:0xf
    v_add_f32_dpp v15, v31, v30 quad_perm:[1,1,3,3] row_mask:0xf bank_mask:0xf
    v_max3_f32 v60, v8, v9, v10
    v_max3_f32 v60, v60, v11, v12
    v_max3_f32 v60, v60, v13, v14
    v_max_f32 v60, v60, v15
    v_mov_b32 v48, 0
    v_mov_b32 v49, 0
    v_max_f32_dpp v60, v60, v60 row_ror:4 row_mask:0xf bank_mask:0xf
    v_mov_b32 v50, 0
    v_mov_b32 v51, 0
    v_max_f32_dpp v60, v60, v60 row_ror:8 row_mask:0xf bank_mask:0xf
    v_mov_b32 v63, v60
    v_mov_b32 v52, 0
    v_mov_b32 v53, 0
    v_permlane16_swap_b32 v60, v63
    v_max_f32 v60, v60, v63
    v_mov_b32 v63, v60
    v_mov_b32 v54, 0
    v_mov_b32 v55, 0
    v_permlane32_swap_b32 v60, v63
    v_max_f32 v60, v60, v63
    v_mul_f32 v60, s57, v60
    v_sub_f32 v60, 0, v60
    v_fma_f32 v8, v8, s57, v60
    v_fma_f32 v9, v9, s57, v60
    v_fma_f32 v10, v10, s57, v60
    v_fma_f32 v11, v11, s57, v60
    v_fma_f32 v12, v12, s57, v60
    v_fma_f32 v13, v13, s57, v60
    v_fma_f32 v14, v14, s57, v60
    v_fma_f32 v15, v15, s57, v60
    v_exp_f32 v8, v8
    v_exp_f32 v9, v9
    v_exp_f32 v10, v10
    v_exp_f32 v11, v11
    v_exp_f32 v12, v12
    v_exp_f32 v13, v13
    v_exp_f32 v14, v14
    v_exp_f32 v15, v15
    v_mov_b32 v56, 0
    v_mov_b32 v57, 0
    v_mov_b32 v58, 0
    v_mov_b32 v59, 0
    v_add_f32 v61, v8, v9
    v_add_f32 v63, v10, v11
    v_add_f32 v61, v61, v12
    v_add_f32 v63, v63, v13
    v_add_f32 v61, v61, v14
    v_add_f32 v63, v63, v15
    v_cvt_pk_bf16_f32 v8, v8, v8
    v_cvt_pk_bf16_f32 v9, v9, v9
    v_cvt_pk_bf16_f32 v10, v10, v10
    v_cvt_pk_bf16_f32 v11, v11, v11
    v_cvt_pk_bf16_f32 v12, v12, v12
    v_cvt_pk_bf16_f32 v13, v13, v13
    v_cvt_pk_bf16_f32 v14, v14, v14
    v_cvt_pk_bf16_f32 v15, v15, v15
    v_add_f32 v61, v61, v63
    v_and_b32_dpp v8, v8, v62 quad_perm:[0,0,2,2] row_mask:0xf bank_mask:0xf
    v_and_b32_dpp v9, v9, v62 quad_perm:[0,0,2,2] row_mask:0xf bank_mask:0xf
    v_and_b32_dpp v10, v10, v62 quad_perm:[0,0,2,2] row_mask:0xf bank_mask:0xf
    v_and_b32_dpp v11, v11, v62 quad_perm:[0,0,2,2] row_mask:0xf bank_mask:0xf
    v_and_b32_dpp v12, v12, v62 quad_perm:[0,0,2,2] row_mask:0xf bank_mask:0xf
    v_and_b32_dpp v13, v13, v62 quad_perm:[0,0,2,2] row_mask:0xf bank_mask:0xf
    v_and_b32_dpp v14, v14, v62 quad_perm:[0,0,2,2] row_mask:0xf bank_mask:0xf
    v_and_b32_dpp v15, v15, v62 quad_perm:[0,0,2,2] row_mask:0xf bank_mask:0xf
    s_setpc_b64 s[64:65]
sub_pv01:
    v_mov_b32_dpp v48, v8 quad_perm:[0,1,2,3] row_mask:0xf bank_mask:0x1
    v_mov_b32_dpp v49, v8 row_shr:4 row_mask:0xf bank_mask:0x2
    v_mov_b32_dpp v50, v8 row_shr:8 row_mask:0xf bank_mask:0x4
    v_mov_b32_dpp v51, v8 row_shr:12 row_mask:0xf bank_mask:0x8
    v_mov_b32_dpp v52, v9 quad_perm:[0,1,2,3] row_mask:0xf bank_mask:0x1
    v_mov_b32_dpp v53, v9 row_shr:4 row_mask:0xf bank_mask:0x2
    v_mov_b32_dpp v54, v9 row_shr:8 row_mask:0xf bank_mask:0x4
    v_mov_b32_dpp v55, v9 row_shr:12 row_mask:0xf bank_mask:0x8
    v_mfma_f32_16x16x32_bf16 v[40:43], v[64:67], v[48:51], v[40:43]
    v_mov_b32_dpp v56, v10 quad_perm:[0,1,2,3] row_mask:0xf bank_mask:0x1
    v_mov_b32_dpp v57, v10 row_shr:4 row_mask:0xf bank_mask:0x2
    v_mfma_f32_16x16x32_bf16 v[44:47], v[68:71], v[48:51], v[44:47]
    v_mov_b32_dpp v58, v10 row_shr:8 row_mask:0xf bank_mask:0x4
    v_mov_b32_dpp v59, v10 row_shr:12 row_mask:0xf bank_mask:0x8
    v_mfma_f32_16x16x32_bf16 v[40:43], v[72:75], v[52:55], v[40:43]
    v_mov_b32_dpp v48, v11 quad_perm:[0,1,2,3] row_mask:0xf bank_mask:0x1
    v_mov_b32_dpp v49, v11 row_shr:4 row_mask:0xf bank_mask:0x2
    v_mfma_f32_16x16x32_bf16 v[44:47], v[76:79], v[52:55], v[44:47]
    v_mov_b32_dpp v50, v11 row_shr:8 row_mask:0xf bank_mask:0x4
    v_mov_b32_dpp v51, v11 row_shr:12 row_mask:0xf bank_mask:0x8
    v_mfma_f32_16x16x32_bf16 v[40:43], v[80:83], v[56:59], v[40:43]
    v_mov_b32_dpp v52, v8 row_shl:4 row_mask:0xf bank_mask:0x1
    v_mov_b32_dpp v53, v8 quad_perm:[0,1,2,3] row_mask:0xf bank_mask:0x2
    v_mfma_f32_16x16x32_bf16 v[44:47], v[84:87], v[56:59], v[44:47]
    v_mov_b32_dpp v54, v8 row_shr:4 row_mask:0xf bank_mask:0x4
    v_mov_b32_dpp v55, v8 row_shr:8 row_mask:0xf bank_mask:0x8
    v_mfma_f32_16x16x32_bf16 v[40:43], v[88:91], v[48:51], v[40:43]
    v_mov_b32_dpp v56, v9 row_shl:4 row_mask:0xf bank_mask:0x1
    v_mov_b32_dpp v57, v9 quad_perm:[0,1,2,3] row_mask:0xf bank_mask:0x2
    v_mfma_f32_16x16x32_bf16 v[44:47], v[92:95], v[48:51], v[44:47]
    v_mov_b32_dpp v58, v9 row_shr:4 row_mask:0xf bank_mask:0x4
    v_mov_b32_dpp v59, v9 row_shr:8 row_mask:0xf bank_mask:0x8
    v_mfma_f32_16x16x32_bf16 v[40:43], v[96:99], v[52:55], v[40:43]
    v_mov_b32_dpp v48, v10 row_shl:4 row_mask:0xf bank_mask:0x1
    v_mov_b32_dpp v49, v10 quad_perm:[0,1,2,3] row_mask:0xf bank_mask:0x2
    v_mfma_f32_16x16x32_bf16 v[44:47], v[100:103], v[52:55], v[44:47]
    v_mov_b32_dpp v50, v10 row_shr:4 row_mask:0xf bank_mask:0x4
    v_mov_b32_dpp v51, v10 row_shr:8 row_mask:0xf bank_mask:0x8
    v_mfma_f32_16x16x32_bf16 v[40:43], v[104:107], v[56:59], v[40:43]
    v_mov_b32_dpp v52, v11 row_shl:4 row_mask:0xf bank_mask:0x1
    v_mov_b32_dpp v53, v11 quad_perm:[0,1,2,3] row_mask:0xf bank_mask:0x2
    v_mfma_f32_16x16x32_bf16 v[44:47], v[108:111], v[56:59], v[44:47]
    v_mov_b32_dpp v54, v11 row_shr:4 row_mask:0xf bank_mask:0x4
    v_mov_b32_dpp v55, v11 row_shr:8 row_mask:0xf bank_mask:0x8
    v_mfma_f32_16x16x32_bf16 v[40:43], v[112:115], v[48:51], v[40:43]
    v_mov_b32_dpp v56, v8 row_shl:8 row_mask:0xf bank_mask:0x1
    v_mov_b32_dpp v57, v8 row_shl:4 row_mask:0xf bank_mask:0x2
    v_mfma_f32_16x16x32_bf16 v[44:47], v[116:119], v[48:51], v[44:47]
    v_mov_b32_dpp v58, v8 quad_perm:[0,1,2,3] row_mask:0xf bank_mask:0x4
    v_mov_b32_dpp v59, v8 row_shr:4 row_mask:0xf bank_mask:0x8
    v_mfma_f32_16x16x32_bf16 v[40:43], v[120:123], v[52:55], v[40:43]
    v_mov_b32_dpp v48, v9 row_shl:8 row_mask:0xf bank_mask:0x1
    v_mov_b32_dpp v49, v9 row_shl:4 row_mask:0xf bank_mask:0x2
    v_mfma_f32_16x16x32_bf16 v[44:47], v[124:127], v[52:55], v[44:47]
    v_mov_b32_dpp v50, v9 quad_perm:[0,1,2,3] row_mask:0xf bank_mask:0x4
    v_mov_b32_dpp v51, v9 row_shr:4 row_mask:0xf bank_mask:0x8
    s_setpc_b64 s[64:65]
sub_pv23:
    v_mfma_f32_16x16x32_bf16 v[40:43], v[128:131], v[56:59], v[40:43]
    v_mov_b32_dpp v52, v10 row_shl:8 row_mask:0xf bank_mask:0x1
    v_mov_b32_dpp v53, v10 row_shl:4 row_mask:0xf bank_mask:0x2
    v_mfma_f32_16x16x32_bf16 v[44:47], v[132:135], v[56:59], v[44:47]
    v_mov_b32_dpp v54, v10 quad_perm:[0,1,2,3] row_mask:0xf bank_mask:0x4
    v_mov_b32_dpp v55, v10 row_shr:4 row_mask:0xf bank_mask:0x8
    v_mfma_f32_16x16x32_bf16 v[40:43], v[136:139], v[48:51], v[40:43]
    v_mov_b32_dpp v56, v11 row_shl:8 row_mask:0xf bank_mask:0x1
    v_mov_b32_dpp v57, v11 row_shl:4 row_mask:0xf bank_mask:0x2
    v_mfma_f32_16x16x32_bf16 v[44:47], v[140:143], v[48:51], v[44:47]
    v_mov_b32_dpp v58, v11 quad_perm:[0,1,2,3] row_mask:0xf bank_mask:0x4
    v_mov_b32_dpp v59, v11 row_shr:4 row_mask:0xf bank_mask:0x8
    v_mfma_f32_16x16x32_bf16 v[40:43], v[144:147], v[52:55], v[40:43]
    v_mov_b32_dpp v48, v8 row_shl:12 row_mask:0xf bank_mask:0x1
    v_mov_b32_dpp v49, v8 row_shl:8 row_mask:0xf bank_mask:0x2
    v_mfma_f32_16x16x32_bf16 v[44:47], v[148:151], v[52:55], v[44:47]
    v_mov_b32_dpp v50, v8 row_shl:4 row_mask:0xf bank_mask:0x4
    v_mov_b32_dpp v51, v8 quad_perm:[0,1,2,3] row_mask:0xf bank_mask:0x8
    v_mfma_f32_16x16x32_bf16 v[40:43], v[152:155], v[56:59], v[40:43]
    v_mov_b32_dpp v52, v9 row_shl:12 row_mask:0xf bank_mask:0x1
    v_mov_b32_dpp v53, v9 row_shl:8 row_mask:0xf bank_mask:0x2
    v_mfma_f32_16x16x32_bf16 v[44:47], v[156:159], v[56:59], v[44:47]
    v_mov_b32_dpp v54, v9 row_shl:4 row_mask:0xf bank_mask:0x4
    v_mov_b32_dpp v55, v9 quad_perm:[0,1,2,3] row_mask:0xf bank_mask:0x8
    v_mfma_f32_16x16x32_bf16 v[40:43], v[160:163], v[48:51], v[40:43]
    v_mov_b32_dpp v56, v10 row_shl:12 row_mask:0xf bank_mask:0x1
    v_mov_b32_dpp v57, v10 row_shl:8 row_mask:0xf bank_mask:0x2
    v_mfma_f32_16x16x32_bf16 v[44:47], v[164:167], v[48:51], v[44:47]
    v_mov_b32_dpp v58, v10 row_shl:4 row_mask:0xf bank_mask:0x4
    v_mov_b32_dpp v59, v10 quad_perm:[0,1,2,3] row_mask:0xf bank_mask:0x8
    v_mfma_f32_16x16x32_bf16 v[40:43], v[168:171], v[52:55], v[40:43]
    v_mov_b32_dpp v48, v11 row_shl:12 row_mask:0xf bank_mask:0x1
    v_mov_b32_dpp v49, v11 row_shl:8 row_mask:0xf bank_mask:0x2
    v_mfma_f32_16x16x32_bf16 v[44:47], v[172:175], v[52:55], v[44:47]
    v_mov_b32_dpp v50, v11 row_shl:4 row_mask:0xf bank_mask:0x4
    v_mov_b32_dpp v51, v11 quad_perm:[0,1,2,3] row_mask:0xf bank_mask:0x8
    v_mfma_f32_16x16x32_bf16 v[40:43], v[176:179], v[56:59], v[40:43]
    v_mov_b32_dpp v52, v12 quad_perm:[0,1,2,3] row_mask:0xf bank_mask:0x1
    v_mov_b32_dpp v53, v12 row_shr:4 row_mask:0xf bank_mask:0x2
    v_mfma_f32_16x16x32_bf16 v[44:47], v[180:183], v[56:59], v[44:47]
    v_mov_b32_dpp v54, v12 row_shr:8 row_mask:0xf bank_mask:0x4
    v_mov_b32_dpp v55, v12 row_shr:12 row_mask:0xf bank_mask:0x8
    v_mfma_f32_16x16x32_bf16 v[40:43], v[184:187], v[48:51], v[40:43]
    v_mov_b32_dpp v56, v13 quad_perm:[0,1,2,3] row_mask:0xf bank_mask:0x1
    v_mov_b32_dpp v57, v13 row_shr:4 row_mask:0xf bank_mask:0x2
    v_mfma_f32_16x16x32_bf16 v[44:47], v[188:191], v[48:51], v[44:47]
    v_mov_b32_dpp v58, v13 row_shr:8 row_mask:0xf bank_mask:0x4
    v_mov_b32_dpp v59, v13 row_shr:12 row_mask:0xf bank_mask:0x8
    s_setpc_b64 s[64:65]
sub_pv4:
    v_bfe_u32 v16, v1, 4, 3
    v_bfe_u32 v17, v1, 7, 1
    v_lshl_add_u32 v16, v17, 5, v16
    v_mul_u32_u24 v16, 896, v16
    v_bfe_u32 v17, v1, 8, 2
    v_lshl_add_u32 v16, v17, 4, v16
    buffer_load_dwordx4 v[24:27], v16, s[32:35], s82 offen
    buffer_load_dwordx4 v[28:31], v16, s[32:35], s83 offen
    buffer_load_dwordx4 v[32:35], v16, s[32:35], s84 offen
    buffer_load_dwordx4 v[36:39], v16, s[32:35], s85 offen
    v_mfma_f32_16x16x32_bf16 v[40:43], v[192:195], v[52:55], v[40:43]
    v_mov_b32_dpp v48, v14 quad_perm:[0,1,2,3] row_mask:0xf bank_mask:0x1
    v_mov_b32_dpp v49, v14 row_shr:4 row_mask:0xf bank_mask:0x2
    v_mfma_f32_16x16x32_bf16 v[44:47], v[196:199], v[52:55], v[44:47]
    v_mov_b32_dpp v50, v14 row_shr:8 row_mask:0xf bank_mask:0x4
    v_mov_b32_dpp v51, v14 row_shr:12 row_mask:0xf bank_mask:0x8
    v_mfma_f32_16x16x32_bf16 v[40:43], v[200:203], v[56:59], v[40:43]
    v_mov_b32_dpp v52, v15 quad_perm:[0,1,2,3] row_mask:0xf bank_mask:0x1
    v_mov_b32_dpp v53, v15 row_shr:4 row_mask:0xf bank_mask:0x2
    v_mfma_f32_16x16x32_bf16 v[44:47], v[204:207], v[56:59], v[44:47]
    v_mov_b32_dpp v54, v15 row_shr:8 row_mask:0xf bank_mask:0x4
    v_mov_b32_dpp v55, v15 row_shr:12 row_mask:0xf bank_mask:0x8
    v_mfma_f32_16x16x32_bf16 v[40:43], v[208:211], v[48:51], v[40:43]
    v_mov_b32_dpp v56, v12 row_shl:4 row_mask:0xf bank_mask:0x1
    v_mov_b32_dpp v57, v12 quad_perm:[0,1,2,3] row_mask:0xf bank_mask:0x2
    v_mfma_f32_16x16x32_bf16 v[44:47], v[212:215], v[48:51], v[44:47]
    v_mov_b32_dpp v58, v12 row_shr:4 row_mask:0xf bank_mask:0x4
    v_mov_b32_dpp v59, v12 row_shr:8 row_mask:0xf bank_mask:0x8
    v_mfma_f32_16x16x32_bf16 v[40:43], v[216:219], v[52:55], v[40:43]
    v_mov_b32_dpp v48, v13 row_shl:4 row_mask:0xf bank_mask:0x1
    v_mov_b32_dpp v49, v13 quad_perm:[0,1,2,3] row_mask:0xf bank_mask:0x2
    v_mfma_f32_16x16x32_bf16 v[44:47], v[220:223], v[52:55], v[44:47]
    v_mov_b32_dpp v50, v13 row_shr:4 row_mask:0xf bank_mask:0x4
    v_mov_b32_dpp v51, v13 row_shr:8 row_mask:0xf bank_mask:0x8
    s_setpc_b64 s[64:65]
sub_pv5:
    v_mfma_f32_16x16x32_bf16 v[40:43], v[224:227], v[56:59], v[40:43]
    v_mov_b32_dpp v52, v14 row_shl:4 row_mask:0xf bank_mask:0x1
    v_mov_b32_dpp v53, v14 quad_perm:[0,1,2,3] row_mask:0xf bank_mask:0x2
    v_mfma_f32_16x16x32_bf16 v[44:47], v[228:231], v[56:59], v[44:47]
    v_mov_b32_dpp v54, v14 row_shr:4 row_mask:0xf bank_mask:0x4
    v_mov_b32_dpp v55, v14 row_shr:8 row_mask:0xf bank_mask:0x8
    v_mfma_f32_16x16x32_bf16 v[40:43], v[232:235], v[48:51], v[40:43]
    v_mov_b32_dpp v56, v15 row_shl:4 row_mask:0xf bank_mask:0x1
    v_mov_b32_dpp v57, v15 quad_perm:[0,1,2,3] row_mask:0xf bank_mask:0x2
    v_mfma_f32_16x16x32_bf16 v[44:47], v[236:239], v[48:51], v[44:47]
    v_mov_b32_dpp v58, v15 row_shr:4 row_mask:0xf bank_mask:0x4
    v_mov_b32_dpp v59, v15 row_shr:8 row_mask:0xf bank_mask:0x8
    v_mfma_f32_16x16x32_bf16 v[40:43], v[240:243], v[52:55], v[40:43]
    v_mfma_f32_16x16x32_bf16 v[44:47], v[244:247], v[52:55], v[44:47]
    v_mfma_f32_16x16x32_bf16 v[40:43], v[248:251], v[56:59], v[40:43]
    v_mfma_f32_16x16x32_bf16 v[44:47], v[252:255], v[56:59], v[44:47]
    s_branch .Lchain
.ss7:
    buffer_store_dwordx4 v[48:51], v9, s[24:27], s69 offen sc1
    s_branch .sb8
.pr9:
    s_cmp_ge_u32 s89, 4
    s_cbranch_scc1 .Lev_x
    v_cmp_ne_u32 s[0:1], 0, v58
    s_nop 1
    s_bcnt1_i32_b64 s60, s[0:1]
    s_cmp_lt_u32 s60, 16
    s_cbranch_scc1 .Lev_x
    s_mov_b64 exec, -1
    s_mov_b32 s50, s55
    s_mov_b32 s51, s63
    s_mov_b32 s67, s89
    s_call_b64 s[64:65], sub_job
    s_add_u32 s89, s89, 1
.Lev_x:
    s_wqm_b64 exec, vcc
    buffer_load_dwordx3 v[56:58], v63, s[24:27], s71 offen sc1
    buffer_load_dwordx4 v[8:11], v62, s[24:27], s78 offen offset:0 sc1
    buffer_load_dwordx4 v[12:15], v62, s[24:27], s78 offen offset:2048 sc1
    buffer_load_dwordx4 v[16:19], v62, s[24:27], s79 offen offset:0 sc1
    buffer_load_dwordx4 v[20:23], v62, s[24:27], s79 offen offset:2048 sc1
    buffer_load_dwordx4 v[40:43], v62, s[24:27], s80 offen offset:0 sc1
    buffer_load_dwordx4 v[44:47], v62, s[24:27], s80 offen offset:2048 sc1
    buffer_load_dwordx4 v[4:7], v62, s[24:27], s81 offen offset:0 sc1
    buffer_load_dwordx4 v[52:55], v62, s[24:27], s81 offen offset:2048 sc1
    s_mov_b64 s[40:41], exec
    s_mov_b64 exec, -1
    s_sub_u32 s62, s62, 1
    s_cbranch_scc0 .pw11
    s_mov_b32 s62, 0
    s_waitcnt vmcnt(0)
    s_branch .pd10
.Ls1_other:
    s_waitcnt lgkmcnt(0)
    s_barrier
    s_branch .Lloader
.pr12:
    s_mov_b64 exec, vcc
    buffer_load_dwordx4 v[44:47], v7, s[36:39], 0 offen sc1
    buffer_load_dwordx4 v[48:51], v7, s[36:39], 0 offen offset:16 sc1
    s_sub_u32 s62, s62, 1
    s_cbranch_scc0 .pw14
    s_mov_b32 s62, 0
    s_waitcnt vmcnt(0)
    s_branch .pd13
.ss15:
    buffer_store_dwordx4 v[40:43], v48, s[24:27], s77 offen sc1
    s_branch .sb16
.pr17:
    s_mov_b64 exec, vcc
    buffer_load_dwordx4 v[40:43], v50, s[36:39], 0 offen sc1
    buffer_load_dwordx4 v[44:47], v50, s[36:39], 0 offen offset:16 sc1
    s_sub_u32 s62, s62, 1
    s_cbranch_scc0 .pw19
    s_mov_b32 s62, 0
    s_waitcnt vmcnt(0)
    s_branch .pd18
.pr30:
    s_wqm_b64 exec, vcc
    buffer_load_dwordx4 v[44:47], v2, s[24:27], s73 offen sc1
    buffer_load_dwordx4 v[48:51], v2, s[24:27], s74 offen sc1
    s_sub_u32 s62, s62, 1
    s_cbranch_scc0 .pw32
    s_mov_b32 s62, 0
    s_waitcnt vmcnt(0)
    s_branch .pd31
.ss33:
    buffer_store_dwordx2 v[44:45], v43, s[24:27], s75 offen sc1
    s_branch .sb34
sub_dmaX:
    s_add_u32 m0, s51, 0
    s_nop 0
    buffer_load_dwordx4 v3, s[12:15], s50 offen offset:0  lds
    s_add_u32 m0, s51, 768
    s_nop 0
    buffer_load_dwordx4 v3, s[12:15], s50 offen offset:256  lds
    s_add_u32 m0, s51, 1536
    s_nop 0
    buffer_load_dwordx4 v3, s[12:15], s50 offen offset:512  lds
    s_add_u32 m0, s51, 2304
    s_nop 0
    buffer_load_dwordx4 v3, s[12:15], s50 offen offset:768  lds
    s_add_u32 m0, s51, 3072
    s_nop 0
    buffer_load_dwordx4 v3, s[12:15], s50 offen offset:1024  lds
    s_add_u32 m0, s51, 3840
    s_nop 0
    buffer_load_dwordx4 v3, s[12:15], s50 offen offset:1280  lds
    s_add_u32 m0, s51, 4608
    s_nop 0
    buffer_load_dwordx4 v3, s[12:15], s50 offen offset:1536  lds
    s_add_u32 m0, s51, 5376
    s_nop 0
    buffer_load_dwordx4 v3, s[12:15], s50 offen offset:1792  lds
    s_setpc_b64 s[64:65]
sub_job:
    s_cmp_ge_u32 s67, 2
    s_cbranch_scc1 .Ljob_v
    s_lshl_b32 s56, s67, 20
    s_add_u32 s50, s50, s56
    s_lshl_b32 s56, s67, 13
    s_add_u32 s51, s51, s56
    s_add_u32 m0, s51, 0
    s_nop 0
    buffer_load_dwordx4 v2, s[16:19], s50 offen offset:0 nt lds
    s_add_u32 m0, s51, 0
    s_nop 0
    buffer_load_dwordx4 v2, s[16:19], s50 offen offset:1024 nt lds
    s_add_u32 m0, s51, 1920
    s_nop 0
    buffer_load_dwordx4 v2, s[16:19], s50 offen offset:128 nt lds
    s_add_u32 m0, s51, 1920
    s_nop 0
    buffer_load_dwordx4 v2, s[16:19], s50 offen offset:1152 nt lds
    s_add_u32 m0, s51, 3840
    s_nop 0
    buffer_load_dwordx4 v2, s[16:19], s50 offen offset:256 nt lds
    s_add_u32 m0, s51, 3840
    s_nop 0
    buffer_load_dwordx4 v2, s[16:19], s50 offen offset:1280 nt lds
    s_add_u32 m0, s51, 5760
    s_nop 0
    buffer_load_dwordx4 v2, s[16:19], s50 offen offset:384 nt lds
    s_add_u32 m0, s51, 5760
    s_nop 0
    buffer_load_dwordx4 v2, s[16:19], s50 offen offset:1408 nt lds
    s_setpc_b64 s[64:65]
.Ljob_v:
    s_cmp_eq_u32 s67, 2
    s_cbranch_scc0 .Ljob_v1
    s_add_u32 m0, s51, 65536
    s_nop 0
    buffer_load_dwordx4 v3, s[20:23], s50 offen offset:0 nt lds
    s_add_u32 m0, s51, 66304
    s_nop 0
    buffer_load_dwordx4 v3, s[20:23], s50 offen offset:256 nt lds
    s_add_u32 m0, s51, 67072
    s_nop 0
    buffer_load_dwordx4 v3, s[20:23], s50 offen offset:512 nt lds
    s_add_u32 m0, s51, 67840
    s_nop 0
    buffer_load_dwordx4 v3, s[20:23], s50 offen offset:768 nt lds
    s_add_u32 m0, s51, 68608
    s_nop 0
    buffer_load_dwordx4 v3, s[20:23], s50 offen offset:1024 nt lds
    s_add_u32 m0, s51, 69376
    s_nop 0
    buffer_load_dwordx4 v3, s[20:23], s50 offen offset:1280 nt lds
    s_add_u32 m0, s51, 70144
    s_nop 0
    buffer_load_dwordx4 v3, s[20:23], s50 offen offset:1536 nt lds
    s_add_u32 m0, s51, 70912
    s_nop 0
    buffer_load_dwordx4 v3, s[20:23], s50 offen offset:1792 nt lds
    s_setpc_b64 s[64:65]
.Ljob_v1:
    s_add_u32 s50, s50, 1048576
    s_add_u32 m0, s51, 75264
    s_nop 0
    buffer_load_dwordx4 v3, s[20:23], s50 offen offset:512 nt lds
    s_add_u32 m0, s51, 76032
    s_nop 0
    buffer_load_dwordx4 v3, s[20:23], s50 offen offset:768 nt lds
    s_add_u32 m0, s51, 76800
    s_nop 0
    buffer_load_dwordx4 v3, s[20:23], s50 offen offset:1024 nt lds
    s_add_u32 m0, s51, 77568
    s_nop 0
    buffer_load_dwordx4 v3, s[20:23], s50 offen offset:1280 nt lds
    s_add_u32 m0, s51, 78336
    s_nop 0
    buffer_load_dwordx4 v3, s[20:23], s50 offen offset:1536 nt lds
    s_add_u32 m0, s51, 79104
    s_nop 0
    buffer_load_dwordx4 v3, s[20:23], s50 offen offset:1792 nt lds
    s_setpc_b64 s[64:65]
sub_repair:
    s_add_u32 s50, s55, 786432
    s_mov_b32 m0, 73728
    s_nop 0
    buffer_load_dwordx4 v3, s[20:23], s50 offen offset:0 nt lds
    s_mov_b32 m0, 74496
    s_nop 0
    buffer_load_dwordx4 v3, s[20:23], s50 offen offset:256 nt lds
    s_add_u32 s50, s55, 1048576
    s_mov_b32 m0, 90112
    s_nop 0
    buffer_load_dwordx4 v3, s[20:23], s50 offen offset:0 nt lds
    s_mov_b32 m0, 90880
    s_nop 0
    buffer_load_dwordx4 v3, s[20:23], s50 offen offset:256 nt lds
    s_add_u32 s50, s55, 1310720
    s_mov_b32 m0, 106496
    s_nop 0
    buffer_load_dwordx4 v3, s[20:23], s50 offen offset:0 nt lds
    s_mov_b32 m0, 107264
    s_nop 0
    buffer_load_dwordx4 v3, s[20:23], s50 offen offset:256 nt lds
    s_add_u32 s50, s55, 1572864
    s_mov_b32 m0, 122880
    s_nop 0
    buffer_load_dwordx4 v3, s[20:23], s50 offen offset:0 nt lds
    s_mov_b32 m0, 123648
    s_nop 0
    buffer_load_dwordx4 v3, s[20:23], s50 offen offset:256 nt lds
    s_setpc_b64 s[64:65]
sub_breg:
    v_add_u32 v40, s63, v1
    v_add_u32 v41, s66, v1
    ds_read_b128 a[128:131], v40 offset:0
    ds_read_b128 a[132:135], v40 offset:1024
    ds_read_b128 a[136:139], v40 offset:2048
    ds_read_b128 a[140:143], v40 offset:3072
    ds_read_b128 a[144:147], v40 offset:4096
    ds_read_b128 a[148:151], v40 offset:5120
    ds_read_b128 a[152:155], v40 offset:6144
    ds_read_b128 a[156:159], v40 offset:7168
    ds_read_b128 a[160:163], v40 offset:8192
    ds_read_b128 a[164:167], v40 offset:9216
    ds_read_b128 a[168:171], v40 offset:10240
    ds_read_b128 a[172:175], v40 offset:11264
    ds_read_b128 a[176:179], v40 offset:12288
    ds_read_b128 a[180:183], v40 offset:13312
    ds_read_b128 a[184:187], v40 offset:14336
    ds_read_b128 a[188:191], v40 offset:15360
    ds_read_b128 v[64:67], v41 offset:0
    ds_read_b128 v[68:71], v41 offset:1024
    ds_read_b128 v[72:75], v41 offset:2048
    ds_read_b128 v[76:79], v41 offset:3072
    ds_read_b128 v[80:83], v41 offset:4096
    ds_read_b128 v[84:87], v41 offset:5120
    ds_read_b128 v[88:91], v41 offset:6144
    ds_read_b128 v[92:95], v41 offset:7168
    ds_read_b128 v[104:107], v41 offset:10240
    ds_read_b128 v[108:111], v41 offset:11264
    ds_read_b128 v[112:115], v41 offset:12288
    ds_read_b128 v[116:119], v41 offset:13312
    ds_read_b128 v[120:123], v41 offset:14336
    ds_read_b128 v[124:127], v41 offset:15360
    s_setpc_b64 s[64:65]
sub_wq:
    v_lshrrev_b32 v58, 5, v1
    v_lshlrev_b32 v58, 13, v58
    v_and_b32 v59, 16, v1
    v_add_u32 v58, v58, v59
    s_lshl_b32 s56, s4, 10
    s_lshl_b32 s60, s5, 5
    s_add_u32 s56, s56, s60
    s_lshl_b32 s60, s3, 18
    s_add_u32 s56, s56, s60
    s_lshl_b32 s60, s3, 10
    s_add_u32 m0, s51, s60
    s_nop 0
    buffer_load_dwordx4 v58, s[28:31], s56 offen nt lds
    s_add_u32 s56, s56, 1048576
    s_add_u32 m0, m0, 4096
    s_nop 0
    buffer_load_dwordx4 v58, s[28:31], s56 offen nt lds
    s_add_u32 s56, s56, 1048576
    s_add_u32 m0, m0, 4096
    s_nop 0
    buffer_load_dwordx4 v58, s[28:31], s56 offen nt lds
    s_add_u32 s56, s56, 1048576
    s_add_u32 m0, m0, 4096
    s_cmp_ge_u32 s3, 2
    s_cbranch_scc1 .Lwq_end
    s_nop 0
    buffer_load_dwordx4 v58, s[28:31], s56 offen nt lds
.Lwq_end:
    s_setpc_b64 s[64:65]
sub_g0issue:
    s_add_u32 s67, s76, 16384
    v_and_b32 v52, 0x1ff, v1
    v_lshlrev_b32 v49, 1, v1
    buffer_load_dwordx2 v[50:51], v52, s[24:27], s67 offen sc1
    buffer_load_dwordx4 v[40:43], v49, s[24:27], s76 offen sc1
    buffer_load_dwordx4 v[44:47], v49, s[24:27], s76 offen offset:16 sc1
    s_setpc_b64 s[64:65]
sub_g0check:
    v_xor_b32 v48, s86, v40
    v_bitop3_b32 v48, v48, v41, s87 bitop3:0xf6
    v_bitop3_b32 v48, v48, v44, s86 bitop3:0xf6
    v_bitop3_b32 v48, v48, v45, s87 bitop3:0xf6
    v_and_b32 v48, 0xffff, v48
    v_xor_b32 v51, s90, v51
    v_or_b32 v48, v48, v51
    v_cmp_ne_u32 vcc, 0, v48
    s_cbranch_vccz .Lg0ok
    s_cmp_eq_u32 s62, 0
    s_cbranch_scc1 .Lg0bail
    s_sub_u32 s62, s62, 1
    s_setpc_b64 s[64:65]
.Lg0ok:
    s_getreg_b32 s60, hwreg(HW_REG_XCC_ID, 0, 4)
    v_cmp_ne_u32 vcc, s60, v50
    s_nop 1
    s_cmp_eq_u64 vcc, 0
    s_cselect_b32 s58, 1, 0
.Lg0bail:
    v_perm_b32 v40, v41, v40, s7
    v_perm_b32 v41, v43, v42, s7
    v_perm_b32 v42, v45, v44, s7
    v_perm_b32 v43, v47, v46, s7
    v_add_u32 v48, 159872, v1
    ds_write_b128 v48, v[40:43]
    s_add_u32 s56, s58, 1
    v_mov_b32 v50, s56
    v_mov_b32 v53, 159808
    s_waitcnt lgkmcnt(0)
    ds_write_b32 v53, v50
    s_mov_b32 s2, 1
    s_setpc_b64 s[64:65]
.section .rodata,"a"
.p2align 6
.amdhsa_kernel interleave_layers__gqa_block_cached__sliding_block_cached__decode_kernel
  .amdhsa_next_free_vgpr 512
  .amdhsa_next_free_sgpr 102
  .amdhsa_accum_offset 256
  .amdhsa_group_segment_fixed_size 0
  .amdhsa_kernarg_size 104
  .amdhsa_user_sgpr_count 2
  .amdhsa_user_sgpr_kernarg_segment_ptr 1
  .amdhsa_system_sgpr_workgroup_id_x 1
.end_amdhsa_kernel
```
